```python
import torch

def _softmax(x, axis=-1):
    return torch.softmax(x, dim=axis)
def _gelu(x):
    return torch.nn.functional.gelu(x, approximate="tanh")
def _silu(x):
    return torch.nn.functional.silu(x)
def _sigmoid(x):
    return torch.sigmoid(x)
def _layernorm(x, axis=-1, eps=1e-5):
    m = x.mean(dim=axis, keepdim=True)
    v = x.var(dim=axis, keepdim=True, unbiased=False)
    return (x - m) / torch.sqrt(v + eps)
def _scatter_add(tgt, idx, src, axis=0):
    return tgt.clone().index_add_(axis, idx, src)
def _segment_sum(src, seg, n):
    out = torch.zeros((n,) + src.shape[1:], dtype=src.dtype)
    return out.index_add_(0, seg, src)
def _pad(x, pw):
    flat = tuple(v for pair in reversed(pw) for v in pair)
    return torch.nn.functional.pad(x, flat)

kernel_name = 'recurrent_scan__gqa_block_cached__glu_gated_reglu__decode'

def setup_inputs():

    _w = (lambda a: (lambda t: t.to(torch.bfloat16) if t.is_floating_point() else t)(torch.as_tensor(a)))
    def _A_setup():
        B, Sq, D = 8, 1, 512
        Hq, Hkv, Sk, Dh = 32, 8, 8192, 128
        assert Hq % Hkv == 0, (Hq, Hkv)
        return {
            "x": _w((lambda *s: torch.randn(*s, dtype=torch.bfloat16) * 0.2)(B, Sq, D)),
            "k_cache": _w((lambda *s: torch.randn(*s, dtype=torch.bfloat16) * 1.6)(B, Hkv, Sk, Dh)),
            "v_cache": _w((lambda *s: torch.randn(*s, dtype=torch.bfloat16) * 1.6)(B, Hkv, Sk, Dh)),
            "wq": _w((lambda *s: torch.randn(*s, dtype=torch.bfloat16) * 1.6)(D, Hq * Dh) * (D ** -0.5)),
            "wo": _w((lambda *s: torch.randn(*s, dtype=torch.bfloat16) * 1.6)(Hq * Dh, D) * ((Hq * Dh) ** -0.5)),
        }
    _A_in = _A_setup()

    def _B_setup():
        B, S, D, F = 8, 1, 512, 1792
        return {
            "x": _w((lambda *s: torch.randn(*s, dtype=torch.bfloat16) * 0.2)(B, S, D)),
            "W_gate": _w((lambda *s: torch.randn(*s, dtype=torch.bfloat16) * 0.8)(D, F) * (2.0 / D) ** 0.5),
            "W_up": _w((lambda *s: torch.randn(*s, dtype=torch.bfloat16) * 0.8)(D, F) * (2.0 / D) ** 0.5),
            "W_down": _w((lambda *s: torch.randn(*s, dtype=torch.bfloat16) * 0.8)(F, D) * (1.0 / F) ** 0.5),
        }
    _B_in = _B_setup()

    return {
        "A_x": _A_in["x"],
        "A_k_cache": _A_in["k_cache"],
        "A_v_cache": _A_in["v_cache"],
        "A_wq": _A_in["wq"],
        "A_wo": _A_in["wo"],
        "B_x": _B_in["x"],
        "B_W_gate": _B_in["W_gate"],
        "B_W_up": _B_in["W_up"],
        "B_W_down": _B_in["W_down"],
    }

def reference(A_x, A_k_cache, A_v_cache, A_wq, A_wo, B_x, B_W_gate, B_W_up, B_W_down):
    def _A_ref(x, k_cache, v_cache, wq, wo):
        B, Sq, D = x.shape
        Hq, Dh = 32, 128
        Hkv = k_cache.shape[1]
        rep = Hq // Hkv
        q = (lambda x, *d: x.permute(*d))((x @ wq).reshape(B, Sq, Hq, Dh), 0, 2, 1, 3)
        k = (lambda x, n, axis: torch.repeat_interleave(x, n, dim=axis))(k_cache, rep, axis=1)
        v = (lambda x, n, axis: torch.repeat_interleave(x, n, dim=axis))(v_cache, rep, axis=1)
        scores = torch.einsum("bhqd,bhkd->bhqk", q, k) * (Dh ** -0.5)
        p = _softmax(scores, axis=-1)
        o = torch.einsum("bhqk,bhkd->bhqd", p, v)
        return (lambda x, *d: x.permute(*d))(o, 0, 2, 1, 3).reshape(B, Sq, Hq * Dh) @ wo

    def _B_ref(x, W_gate, W_up, W_down):
        gate = torch.einsum("bsd,df->bsf", x, W_gate)
        up = torch.einsum("bsd,df->bsf", x, W_up)
        gate = gate * (lambda x, dt: x.to(dt))(gate > 0, gate.dtype)
        h = gate * up
        return torch.einsum("bsf,fd->bsd", h, W_down)

    x = A_x
    xn = _layernorm(x, axis=-1)
    s = _A_ref(xn, A_k_cache, A_v_cache, A_wq, A_wo)
    g = _silu(_B_ref(xn, B_W_gate, B_W_up, B_W_down))
    return x + s * g
```

```asm
; @launch grid=(256,1,1) block=(512,1,1) lds=36096
.amdgcn_target "amdgcn-amd-amdhsa--gfx950"
.text
.globl recurrent_scan__gqa_block_cached__glu_gated_reglu__decode_kernel
.p2align 8
.type recurrent_scan__gqa_block_cached__glu_gated_reglu__decode_kernel,@function
recurrent_scan__gqa_block_cached__glu_gated_reglu__decode_kernel:
  s_cmp_ge_u32 s2, 256
  s_cbranch_scc1 L_end2
  s_load_dwordx16 s[4:19], s[0:1], 0
  s_load_dwordx8 s[20:27], s[0:1], 64
  v_and_b32 v1, 63, v0
  v_lshrrev_b32 v2, 6, v0
  v_and_b32 v3, 15, v1
  v_lshrrev_b32 v4, 4, v1
  v_readfirstlane_b32 s60, v2
  s_lshr_b32 s61, s2, 2
  s_and_b32 s62, s2, 3
  s_lshr_b32 s63, s61, 3
  s_and_b32 s64, s61, 7
  s_mov_b32 s70, 0x05040100
  s_mov_b32 s71, 0x07060302
  s_mov_b32 s72, 0x3db504f3
  s_mov_b32 s73, 0x3fb8aa3b
  v_lshlrev_b32 v5, 6, v3
  v_lshl_add_u32 v5, v4, 4, v5
  v_lshlrev_b32 v6, 8, v4
  v_lshl_add_u32 v6, v3, 4, v6
  s_lshl_b32 s74, s61, 21
  s_lshl_b32 s84, s62, 19
  s_add_u32 s74, s74, s84
  s_lshl_b32 s84, s60, 16
  s_add_u32 s74, s74, s84
  s_lshr_b32 s84, s2, 2
  s_add_u32 s84, s84, s2
  s_add_u32 s84, s84, s60
  s_and_b32 s84, s84, 7
  s_lshl_b32 s84, s84, 13
  s_add_u32 s74, s74, s84
  s_add_u32 s75, s74, 4096
  s_mov_b32 s76, s74
  s_mov_b32 s77, s75
  s_waitcnt lgkmcnt(0)
  s_mov_b32 s28, s6
  s_mov_b32 s29, s7
  s_mov_b32 s30, 0x8000000
  s_mov_b32 s31, 0x00020000
  s_mov_b32 s32, s8
  s_mov_b32 s33, s9
  s_mov_b32 s34, 0x8000000
  s_mov_b32 s35, 0x00020000
  s_mov_b32 s36, s26
  s_mov_b32 s37, s27
  s_mov_b32 s38, 0x20000000
  s_mov_b32 s39, 0x00020000
  s_mov_b32 s40, s24
  s_mov_b32 s41, s25
  s_mov_b32 s42, 0x100
  s_mov_b32 s43, 0x00020000
  s_mov_b32 s44, s4
  s_mov_b32 s45, s5
  s_mov_b32 s46, 0x2000
  s_mov_b32 s47, 0x00020000
  s_mov_b32 s56, s22
  s_mov_b32 s57, s23
  s_mov_b32 s58, 0x2000
  s_mov_b32 s59, 0x00020000
  s_cmp_eq_u32 s60, 0
  s_cbranch_scc1 L_helper
  s_barrier
  buffer_load_dwordx4 v[64:67], v5, s[28:31], s74 offen offset:0 nt
  buffer_load_dwordx4 v[68:71], v5, s[28:31], s74 offen offset:1024 nt
  buffer_load_dwordx4 v[72:75], v5, s[28:31], s74 offen offset:2048 nt
  buffer_load_dwordx4 v[76:79], v5, s[28:31], s74 offen offset:3072 nt
  buffer_load_dwordx4 v[80:83], v5, s[28:31], s75 offen offset:0 nt
  buffer_load_dwordx4 v[84:87], v5, s[28:31], s75 offen offset:1024 nt
  buffer_load_dwordx4 v[88:91], v5, s[28:31], s75 offen offset:2048 nt
  buffer_load_dwordx4 v[92:95], v5, s[28:31], s75 offen offset:3072 nt
  s_add_u32 s99, s74, 8192
  s_and_b32 s99, s99, 0xffff
  s_and_b32 s74, s74, 0xffff0000
  s_or_b32 s74, s74, s99
  s_add_u32 s75, s74, 4096
  buffer_load_dwordx4 v[96:99], v5, s[28:31], s74 offen offset:0 nt
  buffer_load_dwordx4 v[100:103], v5, s[28:31], s74 offen offset:1024 nt
  buffer_load_dwordx4 v[104:107], v5, s[28:31], s74 offen offset:2048 nt
  buffer_load_dwordx4 v[108:111], v5, s[28:31], s74 offen offset:3072 nt
  buffer_load_dwordx4 v[112:115], v5, s[28:31], s75 offen offset:0 nt
  buffer_load_dwordx4 v[116:119], v5, s[28:31], s75 offen offset:1024 nt
  buffer_load_dwordx4 v[120:123], v5, s[28:31], s75 offen offset:2048 nt
  buffer_load_dwordx4 v[124:127], v5, s[28:31], s75 offen offset:3072 nt
  s_add_u32 s99, s74, 8192
  s_and_b32 s99, s99, 0xffff
  s_and_b32 s74, s74, 0xffff0000
  s_or_b32 s74, s74, s99
  s_add_u32 s75, s74, 4096
  buffer_load_dwordx4 v[128:131], v5, s[28:31], s74 offen offset:0 nt
  buffer_load_dwordx4 v[132:135], v5, s[28:31], s74 offen offset:1024 nt
  buffer_load_dwordx4 v[136:139], v5, s[28:31], s74 offen offset:2048 nt
  buffer_load_dwordx4 v[140:143], v5, s[28:31], s74 offen offset:3072 nt
  buffer_load_dwordx4 v[144:147], v5, s[28:31], s75 offen offset:0 nt
  buffer_load_dwordx4 v[148:151], v5, s[28:31], s75 offen offset:1024 nt
  buffer_load_dwordx4 v[152:155], v5, s[28:31], s75 offen offset:2048 nt
  buffer_load_dwordx4 v[156:159], v5, s[28:31], s75 offen offset:3072 nt
  s_add_u32 s99, s74, 8192
  s_and_b32 s99, s99, 0xffff
  s_and_b32 s74, s74, 0xffff0000
  s_or_b32 s74, s74, s99
  s_add_u32 s75, s74, 4096
  buffer_load_dwordx4 v[160:163], v5, s[28:31], s74 offen offset:0 nt
  buffer_load_dwordx4 v[164:167], v5, s[28:31], s74 offen offset:1024 nt
  buffer_load_dwordx4 v[168:171], v5, s[28:31], s74 offen offset:2048 nt
  buffer_load_dwordx4 v[172:175], v5, s[28:31], s74 offen offset:3072 nt
  buffer_load_dwordx4 v[176:179], v5, s[28:31], s75 offen offset:0 nt
  buffer_load_dwordx4 v[180:183], v5, s[28:31], s75 offen offset:1024 nt
  buffer_load_dwordx4 v[184:187], v5, s[28:31], s75 offen offset:2048 nt
  buffer_load_dwordx4 v[188:191], v5, s[28:31], s75 offen offset:3072 nt
  s_add_u32 s99, s74, 8192
  s_and_b32 s99, s99, 0xffff
  s_and_b32 s74, s74, 0xffff0000
  s_or_b32 s74, s74, s99
  s_add_u32 s75, s74, 4096
  s_branch L_join
L_helper:
  v_mov_b32 v8, 0
  s_cmp_lg_u32 s2, 0
  s_cbranch_scc1 L_h_nonon
  s_memrealtime s[98:99]
  s_waitcnt lgkmcnt(0)
  s_or_b32 s98, s98, 1
  v_mov_b32 v2, s98
  s_mov_b64 s[80:81], exec
  s_mov_b64 exec, 1
  buffer_store_dword v2, v8, s[40:43], 0 offen sc1
  s_mov_b64 exec, s[80:81]
  s_branch L_h_non2
L_h_nonon:
  v_mov_b32 v2, 0
L_h_non2:
  s_and_b32 s84, s2, 7
  s_lshr_b32 s85, s2, 3
  s_mov_b32 s48, s10
  s_mov_b32 s49, s11
  s_mov_b32 s50, 0x400000
  s_mov_b32 s51, 0x00020000
  s_cmp_lt_u32 s85, 14
  s_cselect_b32 s86, s16, s18
  s_cselect_b32 s87, s17, s19
  s_cselect_b32 s88, 0, 14
  s_sub_u32 s88, s85, s88
  s_mov_b32 s52, s86
  s_mov_b32 s53, s87
  s_mov_b32 s54, 0x1c0000
  s_mov_b32 s55, 0x00020000
  s_cmp_lt_u32 s2, 224
  s_cbranch_scc1 L_h_guok
  s_mov_b32 s54, 0
L_h_guok:
  v_and_b32 v8, 7, v1
  v_lshrrev_b32 v9, 3, v1
  v_lshlrev_b32 v8, 10, v8
  v_lshl_add_u32 v8, v9, 7, v8
  buffer_load_dwordx4 v[96:99], v8, s[44:47], 0 offen offset:0
  buffer_load_dwordx4 v[100:103], v8, s[44:47], 0 offen offset:16
  buffer_load_dwordx4 v[104:107], v8, s[44:47], 0 offen offset:32
  buffer_load_dwordx4 v[108:111], v8, s[44:47], 0 offen offset:48
  buffer_load_dwordx4 v[112:115], v8, s[44:47], 0 offen offset:64
  buffer_load_dwordx4 v[116:119], v8, s[44:47], 0 offen offset:80
  buffer_load_dwordx4 v[120:123], v8, s[44:47], 0 offen offset:96
  buffer_load_dwordx4 v[124:127], v8, s[44:47], 0 offen offset:112
  v_and_b32 v9, 7, v3
  v_lshlrev_b32 v9, 10, v9
  v_lshl_add_u32 v9, v4, 4, v9
  s_lshl_b32 s89, s84, 7
  buffer_load_dwordx4 v[24:27], v9, s[44:47], s89 offen
  buffer_load_dwordx4 v[28:31], v9, s[44:47], s89 offen offset:64
  v_lshlrev_b32 v10, 16, v4
  v_lshl_add_u32 v10, v3, 4, v10
  s_lshl_b32 s89, s84, 19
  s_lshl_b32 s90, s85, 8
  s_add_u32 s89, s89, s90
  buffer_load_dwordx4 v[192:195], v10, s[48:51], s89 offen
  s_add_u32 s89, s89, 8192
  buffer_load_dwordx4 v[196:199], v10, s[48:51], s89 offen
  s_add_u32 s89, s89, 8192
  buffer_load_dwordx4 v[200:203], v10, s[48:51], s89 offen
  s_add_u32 s89, s89, 8192
  buffer_load_dwordx4 v[204:207], v10, s[48:51], s89 offen
  s_add_u32 s89, s89, 8192
  buffer_load_dwordx4 v[208:211], v10, s[48:51], s89 offen
  s_add_u32 s89, s89, 8192
  buffer_load_dwordx4 v[212:215], v10, s[48:51], s89 offen
  s_add_u32 s89, s89, 8192
  buffer_load_dwordx4 v[216:219], v10, s[48:51], s89 offen
  s_add_u32 s89, s89, 8192
  buffer_load_dwordx4 v[220:223], v10, s[48:51], s89 offen
  s_add_u32 s89, s89, 204800
  buffer_load_dwordx4 v[224:227], v10, s[48:51], s89 offen
  s_add_u32 s89, s89, 8192
  buffer_load_dwordx4 v[228:231], v10, s[48:51], s89 offen
  s_add_u32 s89, s89, 8192
  buffer_load_dwordx4 v[232:235], v10, s[48:51], s89 offen
  s_add_u32 s89, s89, 8192
  buffer_load_dwordx4 v[236:239], v10, s[48:51], s89 offen
  s_add_u32 s89, s89, 8192
  buffer_load_dwordx4 v[240:243], v10, s[48:51], s89 offen
  s_add_u32 s89, s89, 8192
  buffer_load_dwordx4 v[244:247], v10, s[48:51], s89 offen
  s_add_u32 s89, s89, 8192
  buffer_load_dwordx4 v[248:251], v10, s[48:51], s89 offen
  s_add_u32 s89, s89, 8192
  buffer_load_dwordx4 v[252:255], v10, s[48:51], s89 offen
  s_add_u32 s89, s89, 204800
  s_movk_i32 s90, 3584*8
  v_mul_lo_u32 v11, v4, s90
  v_lshl_add_u32 v11, v3, 4, v11
  s_mul_i32 s89, s84, 64*3584
  s_lshl_b32 s90, s88, 8
  s_add_u32 s89, s89, s90
  buffer_load_dwordx4 v[32:35], v11, s[52:55], s89 offen
  s_add_u32 s89, s89, 3584
  buffer_load_dwordx4 v[36:39], v11, s[52:55], s89 offen
  s_add_u32 s89, s89, 3584
  buffer_load_dwordx4 v[40:43], v11, s[52:55], s89 offen
  s_add_u32 s89, s89, 3584
  buffer_load_dwordx4 v[44:47], v11, s[52:55], s89 offen
  s_add_u32 s89, s89, 3584
  buffer_load_dwordx4 v[48:51], v11, s[52:55], s89 offen
  s_add_u32 s89, s89, 3584
  buffer_load_dwordx4 v[52:55], v11, s[52:55], s89 offen
  s_add_u32 s89, s89, 3584
  buffer_load_dwordx4 v[56:59], v11, s[52:55], s89 offen
  s_add_u32 s89, s89, 3584
  buffer_load_dwordx4 v[60:63], v11, s[52:55], s89 offen
  s_add_u32 s89, s89, 89600
  buffer_load_dwordx4 v[64:67], v11, s[52:55], s89 offen
  s_add_u32 s89, s89, 3584
  buffer_load_dwordx4 v[68:71], v11, s[52:55], s89 offen
  s_add_u32 s89, s89, 3584
  buffer_load_dwordx4 v[72:75], v11, s[52:55], s89 offen
  s_add_u32 s89, s89, 3584
  buffer_load_dwordx4 v[76:79], v11, s[52:55], s89 offen
  s_add_u32 s89, s89, 3584
  buffer_load_dwordx4 v[80:83], v11, s[52:55], s89 offen
  s_add_u32 s89, s89, 3584
  buffer_load_dwordx4 v[84:87], v11, s[52:55], s89 offen
  s_add_u32 s89, s89, 3584
  buffer_load_dwordx4 v[88:91], v11, s[52:55], s89 offen
  s_add_u32 s89, s89, 3584
  buffer_load_dwordx4 v[92:95], v11, s[52:55], s89 offen
  s_add_u32 s89, s89, 89600
  s_barrier
  v_lshlrev_b32 v8, 2, v1
  s_waitcnt vmcnt(34)
  v_lshlrev_b32 v128, 16, v96
  v_and_b32 v129, 0xffff0000, v96
  v_lshlrev_b32 v130, 16, v97
  v_and_b32 v131, 0xffff0000, v97
  v_lshlrev_b32 v132, 16, v98
  v_and_b32 v133, 0xffff0000, v98
  v_lshlrev_b32 v134, 16, v99
  v_and_b32 v135, 0xffff0000, v99
  v_lshlrev_b32 v136, 16, v100
  v_and_b32 v137, 0xffff0000, v100
  v_lshlrev_b32 v138, 16, v101
  v_and_b32 v139, 0xffff0000, v101
  v_lshlrev_b32 v140, 16, v102
  v_and_b32 v141, 0xffff0000, v102
  v_lshlrev_b32 v142, 16, v103
  v_and_b32 v143, 0xffff0000, v103
  v_lshlrev_b32 v144, 16, v104
  v_and_b32 v145, 0xffff0000, v104
  v_lshlrev_b32 v146, 16, v105
  v_and_b32 v147, 0xffff0000, v105
  v_lshlrev_b32 v148, 16, v106
  v_and_b32 v149, 0xffff0000, v106
  v_lshlrev_b32 v150, 16, v107
  v_and_b32 v151, 0xffff0000, v107
  v_lshlrev_b32 v152, 16, v108
  v_and_b32 v153, 0xffff0000, v108
  v_lshlrev_b32 v154, 16, v109
  v_and_b32 v155, 0xffff0000, v109
  v_lshlrev_b32 v156, 16, v110
  v_and_b32 v157, 0xffff0000, v110
  v_lshlrev_b32 v158, 16, v111
  v_and_b32 v159, 0xffff0000, v111
  v_lshlrev_b32 v160, 16, v112
  v_and_b32 v161, 0xffff0000, v112
  v_lshlrev_b32 v162, 16, v113
  v_and_b32 v163, 0xffff0000, v113
  v_lshlrev_b32 v164, 16, v114
  v_and_b32 v165, 0xffff0000, v114
  v_lshlrev_b32 v166, 16, v115
  v_and_b32 v167, 0xffff0000, v115
  v_lshlrev_b32 v168, 16, v116
  v_and_b32 v169, 0xffff0000, v116
  v_lshlrev_b32 v170, 16, v117
  v_and_b32 v171, 0xffff0000, v117
  v_lshlrev_b32 v172, 16, v118
  v_and_b32 v173, 0xffff0000, v118
  v_lshlrev_b32 v174, 16, v119
  v_and_b32 v175, 0xffff0000, v119
  v_lshlrev_b32 v176, 16, v120
  v_and_b32 v177, 0xffff0000, v120
  v_lshlrev_b32 v178, 16, v121
  v_and_b32 v179, 0xffff0000, v121
  v_lshlrev_b32 v180, 16, v122
  v_and_b32 v181, 0xffff0000, v122
  v_lshlrev_b32 v182, 16, v123
  v_and_b32 v183, 0xffff0000, v123
  v_lshlrev_b32 v184, 16, v124
  v_and_b32 v185, 0xffff0000, v124
  v_lshlrev_b32 v186, 16, v125
  v_and_b32 v187, 0xffff0000, v125
  v_lshlrev_b32 v188, 16, v126
  v_and_b32 v189, 0xffff0000, v126
  v_lshlrev_b32 v190, 16, v127
  v_and_b32 v191, 0xffff0000, v127
  v_add_f32 v12, v128, v132
  v_add_f32 v13, v129, v133
  v_add_f32 v14, v130, v134
  v_add_f32 v15, v131, v135
  v_add_f32 v12, v12, v136
  v_add_f32 v13, v13, v137
  v_add_f32 v14, v14, v138
  v_add_f32 v15, v15, v139
  v_add_f32 v12, v12, v140
  v_add_f32 v13, v13, v141
  v_add_f32 v14, v14, v142
  v_add_f32 v15, v15, v143
  v_add_f32 v12, v12, v144
  v_add_f32 v13, v13, v145
  v_add_f32 v14, v14, v146
  v_add_f32 v15, v15, v147
  v_add_f32 v12, v12, v148
  v_add_f32 v13, v13, v149
  v_add_f32 v14, v14, v150
  v_add_f32 v15, v15, v151
  v_add_f32 v12, v12, v152
  v_add_f32 v13, v13, v153
  v_add_f32 v14, v14, v154
  v_add_f32 v15, v15, v155
  v_add_f32 v12, v12, v156
  v_add_f32 v13, v13, v157
  v_add_f32 v14, v14, v158
  v_add_f32 v15, v15, v159
  v_add_f32 v12, v12, v160
  v_add_f32 v13, v13, v161
  v_add_f32 v14, v14, v162
  v_add_f32 v15, v15, v163
  v_add_f32 v12, v12, v164
  v_add_f32 v13, v13, v165
  v_add_f32 v14, v14, v166
  v_add_f32 v15, v15, v167
  v_add_f32 v12, v12, v168
  v_add_f32 v13, v13, v169
  v_add_f32 v14, v14, v170
  v_add_f32 v15, v15, v171
  v_add_f32 v12, v12, v172
  v_add_f32 v13, v13, v173
  v_add_f32 v14, v14, v174
  v_add_f32 v15, v15, v175
  v_add_f32 v12, v12, v176
  v_add_f32 v13, v13, v177
  v_add_f32 v14, v14, v178
  v_add_f32 v15, v15, v179
  v_add_f32 v12, v12, v180
  v_add_f32 v13, v13, v181
  v_add_f32 v14, v14, v182
  v_add_f32 v15, v15, v183
  v_add_f32 v12, v12, v184
  v_add_f32 v13, v13, v185
  v_add_f32 v14, v14, v186
  v_add_f32 v15, v15, v187
  v_add_f32 v12, v12, v188
  v_add_f32 v13, v13, v189
  v_add_f32 v14, v14, v190
  v_add_f32 v15, v15, v191
  v_add_f32 v12, v12, v13
  v_add_f32 v14, v14, v15
  v_add_f32 v12, v12, v14
  v_xor_b32 v9, 32, v8
  ds_bpermute_b32 v13, v9, v12
  s_waitcnt lgkmcnt(0)
  v_add_f32 v12, v12, v13
  v_xor_b32 v9, 64, v8
  ds_bpermute_b32 v13, v9, v12
  s_waitcnt lgkmcnt(0)
  v_add_f32 v12, v12, v13
  v_xor_b32 v9, 128, v8
  ds_bpermute_b32 v13, v9, v12
  s_waitcnt lgkmcnt(0)
  v_add_f32 v12, v12, v13
  v_mul_f32 v12, 0x3b000000, v12
  v_mov_b32 v96, 0
  v_mov_b32 v97, 0
  v_mov_b32 v98, 0
  v_mov_b32 v99, 0
  v_sub_f32 v100, v128, v12
  v_sub_f32 v101, v129, v12
  v_sub_f32 v102, v130, v12
  v_sub_f32 v103, v131, v12
  v_fmac_f32 v96, v100, v100
  v_fmac_f32 v97, v101, v101
  v_fmac_f32 v98, v102, v102
  v_fmac_f32 v99, v103, v103
  v_sub_f32 v100, v132, v12
  v_sub_f32 v101, v133, v12
  v_sub_f32 v102, v134, v12
  v_sub_f32 v103, v135, v12
  v_fmac_f32 v96, v100, v100
  v_fmac_f32 v97, v101, v101
  v_fmac_f32 v98, v102, v102
  v_fmac_f32 v99, v103, v103
  v_sub_f32 v100, v136, v12
  v_sub_f32 v101, v137, v12
  v_sub_f32 v102, v138, v12
  v_sub_f32 v103, v139, v12
  v_fmac_f32 v96, v100, v100
  v_fmac_f32 v97, v101, v101
  v_fmac_f32 v98, v102, v102
  v_fmac_f32 v99, v103, v103
  v_sub_f32 v100, v140, v12
  v_sub_f32 v101, v141, v12
  v_sub_f32 v102, v142, v12
  v_sub_f32 v103, v143, v12
  v_fmac_f32 v96, v100, v100
  v_fmac_f32 v97, v101, v101
  v_fmac_f32 v98, v102, v102
  v_fmac_f32 v99, v103, v103
  v_sub_f32 v100, v144, v12
  v_sub_f32 v101, v145, v12
  v_sub_f32 v102, v146, v12
  v_sub_f32 v103, v147, v12
  v_fmac_f32 v96, v100, v100
  v_fmac_f32 v97, v101, v101
  v_fmac_f32 v98, v102, v102
  v_fmac_f32 v99, v103, v103
  v_sub_f32 v100, v148, v12
  v_sub_f32 v101, v149, v12
  v_sub_f32 v102, v150, v12
  v_sub_f32 v103, v151, v12
  v_fmac_f32 v96, v100, v100
  v_fmac_f32 v97, v101, v101
  v_fmac_f32 v98, v102, v102
  v_fmac_f32 v99, v103, v103
  v_sub_f32 v100, v152, v12
  v_sub_f32 v101, v153, v12
  v_sub_f32 v102, v154, v12
  v_sub_f32 v103, v155, v12
  v_fmac_f32 v96, v100, v100
  v_fmac_f32 v97, v101, v101
  v_fmac_f32 v98, v102, v102
  v_fmac_f32 v99, v103, v103
  v_sub_f32 v100, v156, v12
  v_sub_f32 v101, v157, v12
  v_sub_f32 v102, v158, v12
  v_sub_f32 v103, v159, v12
  v_fmac_f32 v96, v100, v100
  v_fmac_f32 v97, v101, v101
  v_fmac_f32 v98, v102, v102
  v_fmac_f32 v99, v103, v103
  v_sub_f32 v100, v160, v12
  v_sub_f32 v101, v161, v12
  v_sub_f32 v102, v162, v12
  v_sub_f32 v103, v163, v12
  v_fmac_f32 v96, v100, v100
  v_fmac_f32 v97, v101, v101
  v_fmac_f32 v98, v102, v102
  v_fmac_f32 v99, v103, v103
  v_sub_f32 v100, v164, v12
  v_sub_f32 v101, v165, v12
  v_sub_f32 v102, v166, v12
  v_sub_f32 v103, v167, v12
  v_fmac_f32 v96, v100, v100
  v_fmac_f32 v97, v101, v101
  v_fmac_f32 v98, v102, v102
  v_fmac_f32 v99, v103, v103
  v_sub_f32 v100, v168, v12
  v_sub_f32 v101, v169, v12
  v_sub_f32 v102, v170, v12
  v_sub_f32 v103, v171, v12
  v_fmac_f32 v96, v100, v100
  v_fmac_f32 v97, v101, v101
  v_fmac_f32 v98, v102, v102
  v_fmac_f32 v99, v103, v103
  v_sub_f32 v100, v172, v12
  v_sub_f32 v101, v173, v12
  v_sub_f32 v102, v174, v12
  v_sub_f32 v103, v175, v12
  v_fmac_f32 v96, v100, v100
  v_fmac_f32 v97, v101, v101
  v_fmac_f32 v98, v102, v102
  v_fmac_f32 v99, v103, v103
  v_sub_f32 v100, v176, v12
  v_sub_f32 v101, v177, v12
  v_sub_f32 v102, v178, v12
  v_sub_f32 v103, v179, v12
  v_fmac_f32 v96, v100, v100
  v_fmac_f32 v97, v101, v101
  v_fmac_f32 v98, v102, v102
  v_fmac_f32 v99, v103, v103
  v_sub_f32 v100, v180, v12
  v_sub_f32 v101, v181, v12
  v_sub_f32 v102, v182, v12
  v_sub_f32 v103, v183, v12
  v_fmac_f32 v96, v100, v100
  v_fmac_f32 v97, v101, v101
  v_fmac_f32 v98, v102, v102
  v_fmac_f32 v99, v103, v103
  v_sub_f32 v100, v184, v12
  v_sub_f32 v101, v185, v12
  v_sub_f32 v102, v186, v12
  v_sub_f32 v103, v187, v12
  v_fmac_f32 v96, v100, v100
  v_fmac_f32 v97, v101, v101
  v_fmac_f32 v98, v102, v102
  v_fmac_f32 v99, v103, v103
  v_sub_f32 v100, v188, v12
  v_sub_f32 v101, v189, v12
  v_sub_f32 v102, v190, v12
  v_sub_f32 v103, v191, v12
  v_fmac_f32 v96, v100, v100
  v_fmac_f32 v97, v101, v101
  v_fmac_f32 v98, v102, v102
  v_fmac_f32 v99, v103, v103
  v_add_f32 v96, v96, v97
  v_add_f32 v98, v98, v99
  v_add_f32 v14, v96, v98
  v_xor_b32 v9, 32, v8
  ds_bpermute_b32 v13, v9, v14
  s_waitcnt lgkmcnt(0)
  v_add_f32 v14, v14, v13
  v_xor_b32 v9, 64, v8
  ds_bpermute_b32 v13, v9, v14
  s_waitcnt lgkmcnt(0)
  v_add_f32 v14, v14, v13
  v_xor_b32 v9, 128, v8
  ds_bpermute_b32 v13, v9, v14
  s_waitcnt lgkmcnt(0)
  v_add_f32 v14, v14, v13
  v_mul_f32 v14, 0x3b000000, v14
  v_cvt_pk_bf16_f32 v13, v12, v14
  v_lshlrev_b32 v12, 16, v13
  v_and_b32 v14, 0xffff0000, v13
  v_add_f32 v14, 0x3727c5ac, v14
  v_cvt_pk_bf16_f32 v13, v14, v14
  v_lshlrev_b32 v14, 16, v13
  v_sqrt_f32 v14, v14
  s_nop 0
  v_cvt_pk_bf16_f32 v13, v14, v14
  v_lshlrev_b32 v14, 16, v13
  v_rcp_f32 v15, v14
  s_waitcnt vmcnt(32)
  v_lshlrev_b32 v96, 16, v24
  v_and_b32 v97, 0xffff0000, v24
  v_lshlrev_b32 v98, 16, v25
  v_and_b32 v99, 0xffff0000, v25
  v_lshlrev_b32 v100, 16, v26
  v_and_b32 v101, 0xffff0000, v26
  v_lshlrev_b32 v102, 16, v27
  v_and_b32 v103, 0xffff0000, v27
  v_lshlrev_b32 v104, 16, v28
  v_and_b32 v105, 0xffff0000, v28
  v_lshlrev_b32 v106, 16, v29
  v_and_b32 v107, 0xffff0000, v29
  v_lshlrev_b32 v108, 16, v30
  v_and_b32 v109, 0xffff0000, v30
  v_lshlrev_b32 v110, 16, v31
  v_and_b32 v111, 0xffff0000, v31
  v_sub_f32 v96, v96, v12
  v_sub_f32 v97, v97, v12
  v_sub_f32 v98, v98, v12
  v_sub_f32 v99, v99, v12
  v_sub_f32 v100, v100, v12
  v_sub_f32 v101, v101, v12
  v_sub_f32 v102, v102, v12
  v_sub_f32 v103, v103, v12
  v_sub_f32 v104, v104, v12
  v_sub_f32 v105, v105, v12
  v_sub_f32 v106, v106, v12
  v_sub_f32 v107, v107, v12
  v_sub_f32 v108, v108, v12
  v_sub_f32 v109, v109, v12
  v_sub_f32 v110, v110, v12
  v_sub_f32 v111, v111, v12
  v_cvt_pk_bf16_f32 v24, v96, v97
  v_cvt_pk_bf16_f32 v25, v98, v99
  v_cvt_pk_bf16_f32 v26, v100, v101
  v_cvt_pk_bf16_f32 v27, v102, v103
  v_cvt_pk_bf16_f32 v28, v104, v105
  v_cvt_pk_bf16_f32 v29, v106, v107
  v_cvt_pk_bf16_f32 v30, v108, v109
  v_cvt_pk_bf16_f32 v31, v110, v111
  v_lshlrev_b32 v96, 16, v24
  v_and_b32 v97, 0xffff0000, v24
  v_lshlrev_b32 v98, 16, v25
  v_and_b32 v99, 0xffff0000, v25
  v_lshlrev_b32 v100, 16, v26
  v_and_b32 v101, 0xffff0000, v26
  v_lshlrev_b32 v102, 16, v27
  v_and_b32 v103, 0xffff0000, v27
  v_lshlrev_b32 v104, 16, v28
  v_and_b32 v105, 0xffff0000, v28
  v_lshlrev_b32 v106, 16, v29
  v_and_b32 v107, 0xffff0000, v29
  v_lshlrev_b32 v108, 16, v30
  v_and_b32 v109, 0xffff0000, v30
  v_lshlrev_b32 v110, 16, v31
  v_and_b32 v111, 0xffff0000, v31
  v_mul_f32 v112, v96, v15
  v_mul_f32 v113, v97, v15
  v_mul_f32 v114, v98, v15
  v_mul_f32 v115, v99, v15
  v_mul_f32 v116, v100, v15
  v_mul_f32 v117, v101, v15
  v_mul_f32 v118, v102, v15
  v_mul_f32 v119, v103, v15
  v_mul_f32 v120, v104, v15
  v_mul_f32 v121, v105, v15
  v_mul_f32 v122, v106, v15
  v_mul_f32 v123, v107, v15
  v_mul_f32 v124, v108, v15
  v_mul_f32 v125, v109, v15
  v_mul_f32 v126, v110, v15
  v_mul_f32 v127, v111, v15
  v_fma_f32 v128, -v112, v14, v96
  v_fma_f32 v129, -v113, v14, v97
  v_fma_f32 v130, -v114, v14, v98
  v_fma_f32 v131, -v115, v14, v99
  v_fma_f32 v132, -v116, v14, v100
  v_fma_f32 v133, -v117, v14, v101
  v_fma_f32 v134, -v118, v14, v102
  v_fma_f32 v135, -v119, v14, v103
  v_fma_f32 v136, -v120, v14, v104
  v_fma_f32 v137, -v121, v14, v105
  v_fma_f32 v138, -v122, v14, v106
  v_fma_f32 v139, -v123, v14, v107
  v_fma_f32 v140, -v124, v14, v108
  v_fma_f32 v141, -v125, v14, v109
  v_fma_f32 v142, -v126, v14, v110
  v_fma_f32 v143, -v127, v14, v111
  v_fma_f32 v112, v128, v15, v112
  v_fma_f32 v113, v129, v15, v113
  v_fma_f32 v114, v130, v15, v114
  v_fma_f32 v115, v131, v15, v115
  v_fma_f32 v116, v132, v15, v116
  v_fma_f32 v117, v133, v15, v117
  v_fma_f32 v118, v134, v15, v118
  v_fma_f32 v119, v135, v15, v119
  v_fma_f32 v120, v136, v15, v120
  v_fma_f32 v121, v137, v15, v121
  v_fma_f32 v122, v138, v15, v122
  v_fma_f32 v123, v139, v15, v123
  v_fma_f32 v124, v140, v15, v124
  v_fma_f32 v125, v141, v15, v125
  v_fma_f32 v126, v142, v15, v126
  v_fma_f32 v127, v143, v15, v127
  v_cvt_pk_bf16_f32 v16, v112, v113
  v_cvt_pk_bf16_f32 v17, v114, v115
  v_cvt_pk_bf16_f32 v18, v116, v117
  v_cvt_pk_bf16_f32 v19, v118, v119
  v_cvt_pk_bf16_f32 v20, v120, v121
  v_cvt_pk_bf16_f32 v21, v122, v123
  v_cvt_pk_bf16_f32 v22, v124, v125
  v_cvt_pk_bf16_f32 v23, v126, v127
  v_lshlrev_b32 v12, 9, v3
  v_lshl_add_u32 v12, v4, 4, v12
  v_cmp_gt_u32 vcc, 8, v3
  s_mov_b64 s[92:93], vcc
  s_waitcnt vmcnt(16)
  v_perm_b32 v128, v196, v192, s70
  v_perm_b32 v129, v204, v200, s70
  v_perm_b32 v130, v212, v208, s70
  v_perm_b32 v131, v220, v216, s70
  v_perm_b32 v132, v196, v192, s71
  v_perm_b32 v133, v204, v200, s71
  v_perm_b32 v134, v212, v208, s71
  v_perm_b32 v135, v220, v216, s71
  v_perm_b32 v136, v197, v193, s70
  v_perm_b32 v137, v205, v201, s70
  v_perm_b32 v138, v213, v209, s70
  v_perm_b32 v139, v221, v217, s70
  v_perm_b32 v140, v197, v193, s71
  v_perm_b32 v141, v205, v201, s71
  v_perm_b32 v142, v213, v209, s71
  v_perm_b32 v143, v221, v217, s71
  v_perm_b32 v144, v198, v194, s70
  v_perm_b32 v145, v206, v202, s70
  v_perm_b32 v146, v214, v210, s70
  v_perm_b32 v147, v222, v218, s70
  v_perm_b32 v148, v198, v194, s71
  v_perm_b32 v149, v206, v202, s71
  v_perm_b32 v150, v214, v210, s71
  v_perm_b32 v151, v222, v218, s71
  v_perm_b32 v152, v199, v195, s70
  v_perm_b32 v153, v207, v203, s70
  v_perm_b32 v154, v215, v211, s70
  v_perm_b32 v155, v223, v219, s70
  v_perm_b32 v156, v199, v195, s71
  v_perm_b32 v157, v207, v203, s71
  v_perm_b32 v158, v215, v211, s71
  v_perm_b32 v159, v223, v219, s71
  s_nop 1
  v_mfma_f32_16x16x32_bf16 v[160:163], v[128:131], v[16:19], 0
  v_mfma_f32_16x16x32_bf16 v[164:167], v[132:135], v[16:19], 0
  v_mfma_f32_16x16x32_bf16 v[168:171], v[136:139], v[16:19], 0
  v_mfma_f32_16x16x32_bf16 v[172:175], v[140:143], v[16:19], 0
  v_mfma_f32_16x16x32_bf16 v[176:179], v[144:147], v[16:19], 0
  v_mfma_f32_16x16x32_bf16 v[180:183], v[148:151], v[16:19], 0
  v_mfma_f32_16x16x32_bf16 v[184:187], v[152:155], v[16:19], 0
  v_mfma_f32_16x16x32_bf16 v[188:191], v[156:159], v[16:19], 0
  v_perm_b32 v128, v228, v224, s70
  v_perm_b32 v129, v236, v232, s70
  v_perm_b32 v130, v244, v240, s70
  v_perm_b32 v131, v252, v248, s70
  v_perm_b32 v132, v228, v224, s71
  v_perm_b32 v133, v236, v232, s71
  v_perm_b32 v134, v244, v240, s71
  v_perm_b32 v135, v252, v248, s71
  v_perm_b32 v136, v229, v225, s70
  v_perm_b32 v137, v237, v233, s70
  v_perm_b32 v138, v245, v241, s70
  v_perm_b32 v139, v253, v249, s70
  v_perm_b32 v140, v229, v225, s71
  v_perm_b32 v141, v237, v233, s71
  v_perm_b32 v142, v245, v241, s71
  v_perm_b32 v143, v253, v249, s71
  v_perm_b32 v144, v230, v226, s70
  v_perm_b32 v145, v238, v234, s70
  v_perm_b32 v146, v246, v242, s70
  v_perm_b32 v147, v254, v250, s70
  v_perm_b32 v148, v230, v226, s71
  v_perm_b32 v149, v238, v234, s71
  v_perm_b32 v150, v246, v242, s71
  v_perm_b32 v151, v254, v250, s71
  v_perm_b32 v152, v231, v227, s70
  v_perm_b32 v153, v239, v235, s70
  v_perm_b32 v154, v247, v243, s70
  v_perm_b32 v155, v255, v251, s70
  v_perm_b32 v156, v231, v227, s71
  v_perm_b32 v157, v239, v235, s71
  v_perm_b32 v158, v247, v243, s71
  v_perm_b32 v159, v255, v251, s71
  s_nop 1
  v_mfma_f32_16x16x32_bf16 v[160:163], v[128:131], v[20:23], v[160:163]
  v_mfma_f32_16x16x32_bf16 v[164:167], v[132:135], v[20:23], v[164:167]
  v_mfma_f32_16x16x32_bf16 v[168:171], v[136:139], v[20:23], v[168:171]
  v_mfma_f32_16x16x32_bf16 v[172:175], v[140:143], v[20:23], v[172:175]
  v_mfma_f32_16x16x32_bf16 v[176:179], v[144:147], v[20:23], v[176:179]
  v_mfma_f32_16x16x32_bf16 v[180:183], v[148:151], v[20:23], v[180:183]
  v_mfma_f32_16x16x32_bf16 v[184:187], v[152:155], v[20:23], v[184:187]
  v_mfma_f32_16x16x32_bf16 v[188:191], v[156:159], v[20:23], v[188:191]
  s_lshl_b32 s89, s84, 5
  s_add_u32 s89, s89, s85
  s_lshl_b32 s89, s89, 12
  s_mov_b64 s[80:81], exec
  s_mov_b64 exec, s[92:93]
  s_nop 4
  buffer_store_dwordx4 v[160:163], v12, s[36:39], s89 offen offset:0 sc1
  buffer_store_dwordx4 v[164:167], v12, s[36:39], s89 offen offset:64 sc1
  buffer_store_dwordx4 v[168:171], v12, s[36:39], s89 offen offset:128 sc1
  buffer_store_dwordx4 v[172:175], v12, s[36:39], s89 offen offset:192 sc1
  buffer_store_dwordx4 v[176:179], v12, s[36:39], s89 offen offset:256 sc1
  buffer_store_dwordx4 v[180:183], v12, s[36:39], s89 offen offset:320 sc1
  buffer_store_dwordx4 v[184:187], v12, s[36:39], s89 offen offset:384 sc1
  buffer_store_dwordx4 v[188:191], v12, s[36:39], s89 offen offset:448 sc1
  s_mov_b64 exec, s[80:81]
  s_waitcnt vmcnt(8)
  v_perm_b32 v128, v36, v32, s70
  v_perm_b32 v129, v44, v40, s70
  v_perm_b32 v130, v52, v48, s70
  v_perm_b32 v131, v60, v56, s70
  v_perm_b32 v132, v36, v32, s71
  v_perm_b32 v133, v44, v40, s71
  v_perm_b32 v134, v52, v48, s71
  v_perm_b32 v135, v60, v56, s71
  v_perm_b32 v136, v37, v33, s70
  v_perm_b32 v137, v45, v41, s70
  v_perm_b32 v138, v53, v49, s70
  v_perm_b32 v139, v61, v57, s70
  v_perm_b32 v140, v37, v33, s71
  v_perm_b32 v141, v45, v41, s71
  v_perm_b32 v142, v53, v49, s71
  v_perm_b32 v143, v61, v57, s71
  v_perm_b32 v144, v38, v34, s70
  v_perm_b32 v145, v46, v42, s70
  v_perm_b32 v146, v54, v50, s70
  v_perm_b32 v147, v62, v58, s70
  v_perm_b32 v148, v38, v34, s71
  v_perm_b32 v149, v46, v42, s71
  v_perm_b32 v150, v54, v50, s71
  v_perm_b32 v151, v62, v58, s71
  v_perm_b32 v152, v39, v35, s70
  v_perm_b32 v153, v47, v43, s70
  v_perm_b32 v154, v55, v51, s70
  v_perm_b32 v155, v63, v59, s70
  v_perm_b32 v156, v39, v35, s71
  v_perm_b32 v157, v47, v43, s71
  v_perm_b32 v158, v55, v51, s71
  v_perm_b32 v159, v63, v59, s71
  s_nop 1
  v_mfma_f32_16x16x32_bf16 v[192:195], v[128:131], v[16:19], 0
  v_mfma_f32_16x16x32_bf16 v[196:199], v[132:135], v[16:19], 0
  v_mfma_f32_16x16x32_bf16 v[200:203], v[136:139], v[16:19], 0
  v_mfma_f32_16x16x32_bf16 v[204:207], v[140:143], v[16:19], 0
  v_mfma_f32_16x16x32_bf16 v[208:211], v[144:147], v[16:19], 0
  v_mfma_f32_16x16x32_bf16 v[212:215], v[148:151], v[16:19], 0
  v_mfma_f32_16x16x32_bf16 v[216:219], v[152:155], v[16:19], 0
  v_mfma_f32_16x16x32_bf16 v[220:223], v[156:159], v[16:19], 0
  v_perm_b32 v128, v68, v64, s70
  v_perm_b32 v129, v76, v72, s70
  v_perm_b32 v130, v84, v80, s70
  v_perm_b32 v131, v92, v88, s70
  v_perm_b32 v132, v68, v64, s71
  v_perm_b32 v133, v76, v72, s71
  v_perm_b32 v134, v84, v80, s71
  v_perm_b32 v135, v92, v88, s71
  v_perm_b32 v136, v69, v65, s70
  v_perm_b32 v137, v77, v73, s70
  v_perm_b32 v138, v85, v81, s70
  v_perm_b32 v139, v93, v89, s70
  v_perm_b32 v140, v69, v65, s71
  v_perm_b32 v141, v77, v73, s71
  v_perm_b32 v142, v85, v81, s71
  v_perm_b32 v143, v93, v89, s71
  v_perm_b32 v144, v70, v66, s70
  v_perm_b32 v145, v78, v74, s70
  v_perm_b32 v146, v86, v82, s70
  v_perm_b32 v147, v94, v90, s70
  v_perm_b32 v148, v70, v66, s71
  v_perm_b32 v149, v78, v74, s71
  v_perm_b32 v150, v86, v82, s71
  v_perm_b32 v151, v94, v90, s71
  v_perm_b32 v152, v71, v67, s70
  v_perm_b32 v153, v79, v75, s70
  v_perm_b32 v154, v87, v83, s70
  v_perm_b32 v155, v95, v91, s70
  v_perm_b32 v156, v71, v67, s71
  v_perm_b32 v157, v79, v75, s71
  v_perm_b32 v158, v87, v83, s71
  v_perm_b32 v159, v95, v91, s71
  s_nop 1
  v_mfma_f32_16x16x32_bf16 v[192:195], v[128:131], v[20:23], v[192:195]
  v_mfma_f32_16x16x32_bf16 v[196:199], v[132:135], v[20:23], v[196:199]
  v_mfma_f32_16x16x32_bf16 v[200:203], v[136:139], v[20:23], v[200:203]
  v_mfma_f32_16x16x32_bf16 v[204:207], v[140:143], v[20:23], v[204:207]
  v_mfma_f32_16x16x32_bf16 v[208:211], v[144:147], v[20:23], v[208:211]
  v_mfma_f32_16x16x32_bf16 v[212:215], v[148:151], v[20:23], v[212:215]
  v_mfma_f32_16x16x32_bf16 v[216:219], v[152:155], v[20:23], v[216:219]
  v_mfma_f32_16x16x32_bf16 v[220:223], v[156:159], v[20:23], v[220:223]
  v_readfirstlane_b32 s91, v2
  s_nop 3
  s_cmp_lg_u32 s91, 0
  s_cbranch_scc1 L_h_non_done
  v_mov_b32 v8, 0
  s_mov_b32 s82, 100000
L_h_non:
  buffer_load_dword v9, v8, s[40:43], 0 offen sc1
  s_waitcnt vmcnt(0)
  v_readfirstlane_b32 s91, v9
  s_nop 3
  s_cmp_lg_u32 s91, 0
  s_cbranch_scc1 L_h_non_done
  s_sleep 1
  s_sub_u32 s82, s82, 1
  s_cmp_eq_u32 s82, 0
  s_cbranch_scc0 L_h_non
L_h_non_done:
  s_waitcnt vmcnt(0)
  s_lshl_b32 s89, s2, 7
  s_add_u32 s89, s89, 0x380000
  v_mov_b32 v8, s89
  v_mov_b32 v9, s91
  s_mov_b64 s[80:81], exec
  s_mov_b64 exec, 1
  buffer_store_dword v9, v8, s[36:39], 0 offen sc1
  s_mov_b64 exec, s[80:81]
  s_cmp_ge_u32 s2, 224
  s_cbranch_scc1 L_h_nogu
  s_mul_i32 s89, s84, 28
  s_add_u32 s89, s89, s85
  s_lshl_b32 s89, s89, 12
  s_add_u32 s89, s89, 0x100000
  s_mov_b64 s[80:81], exec
  s_mov_b64 exec, s[92:93]
  buffer_store_dwordx4 v[192:195], v12, s[36:39], s89 offen offset:0 sc1
  buffer_store_dwordx4 v[196:199], v12, s[36:39], s89 offen offset:64 sc1
  buffer_store_dwordx4 v[200:203], v12, s[36:39], s89 offen offset:128 sc1
  buffer_store_dwordx4 v[204:207], v12, s[36:39], s89 offen offset:192 sc1
  buffer_store_dwordx4 v[208:211], v12, s[36:39], s89 offen offset:256 sc1
  buffer_store_dwordx4 v[212:215], v12, s[36:39], s89 offen offset:320 sc1
  buffer_store_dwordx4 v[216:219], v12, s[36:39], s89 offen offset:384 sc1
  buffer_store_dwordx4 v[220:223], v12, s[36:39], s89 offen offset:448 sc1
  s_mov_b64 exec, s[80:81]
L_h_nogu:
  v_and_b32 v11, 31, v1
  s_lshl_b32 s89, s64, 5
  v_add_u32 v11, s89, v11
  v_lshlrev_b32 v11, 7, v11
  v_add_u32 v11, 0x380000, v11
  s_mov_b64 s[92:93], exec
  s_mov_b32 s82, 100000
  buffer_load_dword v8, v11, s[36:39], 0 offen sc1
L_poll1:
  s_sleep 1
  buffer_load_dword v9, v11, s[36:39], 0 offen sc1
  s_waitcnt vmcnt(1)
  v_cmp_ne_u32 vcc, s91, v8
  s_and_b64 vcc, vcc, s[92:93]
  s_cbranch_scc0 L_poll1_done
  s_sleep 1
  buffer_load_dword v8, v11, s[36:39], 0 offen sc1
  s_waitcnt vmcnt(1)
  v_cmp_ne_u32 vcc, s91, v9
  s_and_b64 vcc, vcc, s[92:93]
  s_cbranch_scc0 L_poll1_done
  s_sub_u32 s82, s82, 1
  s_cmp_eq_u32 s82, 0
  s_cbranch_scc0 L_poll1
L_poll1_done:
  s_waitcnt vmcnt(0)
  v_lshrrev_b32 v10, 5, v1
  v_and_b32 v11, 31, v1
  v_lshlrev_b32 v12, 12, v10
  v_lshl_add_u32 v12, v11, 4, v12
  s_lshl_b32 s89, s64, 14
  s_lshl_b32 s90, s63, 9
  s_add_u32 s89, s89, s90
  s_add_u32 s90, s89, 8192
  buffer_load_dwordx4 v[64:67], v12, s[36:39], s89 offen sc1
  buffer_load_dwordx4 v[96:99], v12, s[36:39], s90 offen sc1
  s_add_u32 s89, s89, 131072
  s_add_u32 s90, s90, 131072
  buffer_load_dwordx4 v[68:71], v12, s[36:39], s89 offen sc1
  buffer_load_dwordx4 v[100:103], v12, s[36:39], s90 offen sc1
  s_add_u32 s89, s89, 131072
  s_add_u32 s90, s90, 131072
  buffer_load_dwordx4 v[72:75], v12, s[36:39], s89 offen sc1
  buffer_load_dwordx4 v[104:107], v12, s[36:39], s90 offen sc1
  s_add_u32 s89, s89, 131072
  s_add_u32 s90, s90, 131072
  buffer_load_dwordx4 v[76:79], v12, s[36:39], s89 offen sc1
  buffer_load_dwordx4 v[108:111], v12, s[36:39], s90 offen sc1
  s_add_u32 s89, s89, 131072
  s_add_u32 s90, s90, 131072
  buffer_load_dwordx4 v[80:83], v12, s[36:39], s89 offen sc1
  buffer_load_dwordx4 v[112:115], v12, s[36:39], s90 offen sc1
  s_add_u32 s89, s89, 131072
  s_add_u32 s90, s90, 131072
  buffer_load_dwordx4 v[84:87], v12, s[36:39], s89 offen sc1
  buffer_load_dwordx4 v[116:119], v12, s[36:39], s90 offen sc1
  s_add_u32 s89, s89, 131072
  s_add_u32 s90, s90, 131072
  buffer_load_dwordx4 v[88:91], v12, s[36:39], s89 offen sc1
  buffer_load_dwordx4 v[120:123], v12, s[36:39], s90 offen sc1
  s_add_u32 s89, s89, 131072
  s_add_u32 s90, s90, 131072
  buffer_load_dwordx4 v[92:95], v12, s[36:39], s89 offen sc1
  buffer_load_dwordx4 v[124:127], v12, s[36:39], s90 offen sc1
  v_and_b32 v13, 3, v11
  v_lshrrev_b32 v14, 2, v11
  v_lshlrev_b32 v13, 5, v13
  v_add_u32 v13, v13, v14
  v_lshl_add_u32 v13, v10, 7, v13
  v_lshlrev_b32 v13, 1, v13
  s_waitcnt vmcnt(0)
  s_lshl_b32 s89, s2, 7
  s_add_u32 s89, s89, 0x3b0000
  v_mov_b32 v8, s89
  v_mov_b32 v9, s91
  s_mov_b64 s[80:81], exec
  s_mov_b64 exec, 1
  buffer_store_dword v9, v8, s[36:39], 0 offen sc1
  s_mov_b64 exec, s[80:81]
  v_add_f32 v64, v64, v68
  v_add_f32 v72, v72, v76
  v_add_f32 v80, v80, v84
  v_add_f32 v88, v88, v92
  v_add_f32 v65, v65, v69
  v_add_f32 v73, v73, v77
  v_add_f32 v81, v81, v85
  v_add_f32 v89, v89, v93
  v_add_f32 v66, v66, v70
  v_add_f32 v74, v74, v78
  v_add_f32 v82, v82, v86
  v_add_f32 v90, v90, v94
  v_add_f32 v67, v67, v71
  v_add_f32 v75, v75, v79
  v_add_f32 v83, v83, v87
  v_add_f32 v91, v91, v95
  v_add_f32 v64, v64, v72
  v_add_f32 v80, v80, v88
  v_add_f32 v65, v65, v73
  v_add_f32 v81, v81, v89
  v_add_f32 v66, v66, v74
  v_add_f32 v82, v82, v90
  v_add_f32 v67, v67, v75
  v_add_f32 v83, v83, v91
  v_add_f32 v64, v64, v80
  v_add_f32 v65, v65, v81
  v_add_f32 v66, v66, v82
  v_add_f32 v67, v67, v83
  v_cvt_pk_bf16_f32 v68, v64, v65
  v_cvt_pk_bf16_f32 v69, v66, v67
  ds_write_b16 v13, v68 offset:33024
  ds_write_b16_d16_hi v13, v68 offset:33040
  ds_write_b16 v13, v69 offset:33056
  ds_write_b16_d16_hi v13, v69 offset:33072
  v_add_f32 v96, v96, v100
  v_add_f32 v104, v104, v108
  v_add_f32 v112, v112, v116
  v_add_f32 v120, v120, v124
  v_add_f32 v97, v97, v101
  v_add_f32 v105, v105, v109
  v_add_f32 v113, v113, v117
  v_add_f32 v121, v121, v125
  v_add_f32 v98, v98, v102
  v_add_f32 v106, v106, v110
  v_add_f32 v114, v114, v118
  v_add_f32 v122, v122, v126
  v_add_f32 v99, v99, v103
  v_add_f32 v107, v107, v111
  v_add_f32 v115, v115, v119
  v_add_f32 v123, v123, v127
  v_add_f32 v96, v96, v104
  v_add_f32 v112, v112, v120
  v_add_f32 v97, v97, v105
  v_add_f32 v113, v113, v121
  v_add_f32 v98, v98, v106
  v_add_f32 v114, v114, v122
  v_add_f32 v99, v99, v107
  v_add_f32 v115, v115, v123
  v_add_f32 v96, v96, v112
  v_add_f32 v97, v97, v113
  v_add_f32 v98, v98, v114
  v_add_f32 v99, v99, v115
  v_cvt_pk_bf16_f32 v100, v96, v97
  v_cvt_pk_bf16_f32 v101, v98, v99
  ds_write_b16 v13, v100 offset:33536
  ds_write_b16_d16_hi v13, v100 offset:33552
  ds_write_b16 v13, v101 offset:33568
  ds_write_b16_d16_hi v13, v101 offset:33584
  s_waitcnt lgkmcnt(0)
  buffer_load_dwordx4 v[64:67], v5, s[28:31], s74 offen offset:0 nt
  buffer_load_dwordx4 v[68:71], v5, s[28:31], s74 offen offset:1024 nt
  buffer_load_dwordx4 v[72:75], v5, s[28:31], s74 offen offset:2048 nt
  buffer_load_dwordx4 v[76:79], v5, s[28:31], s74 offen offset:3072 nt
  buffer_load_dwordx4 v[80:83], v5, s[28:31], s75 offen offset:0 nt
  buffer_load_dwordx4 v[84:87], v5, s[28:31], s75 offen offset:1024 nt
  buffer_load_dwordx4 v[88:91], v5, s[28:31], s75 offen offset:2048 nt
  buffer_load_dwordx4 v[92:95], v5, s[28:31], s75 offen offset:3072 nt
  s_add_u32 s99, s74, 8192
  s_and_b32 s99, s99, 0xffff
  s_and_b32 s74, s74, 0xffff0000
  s_or_b32 s74, s74, s99
  s_add_u32 s75, s74, 4096
  buffer_load_dwordx4 v[96:99], v5, s[28:31], s74 offen offset:0 nt
  buffer_load_dwordx4 v[100:103], v5, s[28:31], s74 offen offset:1024 nt
  buffer_load_dwordx4 v[104:107], v5, s[28:31], s74 offen offset:2048 nt
  buffer_load_dwordx4 v[108:111], v5, s[28:31], s74 offen offset:3072 nt
  buffer_load_dwordx4 v[112:115], v5, s[28:31], s75 offen offset:0 nt
  buffer_load_dwordx4 v[116:119], v5, s[28:31], s75 offen offset:1024 nt
  buffer_load_dwordx4 v[120:123], v5, s[28:31], s75 offen offset:2048 nt
  buffer_load_dwordx4 v[124:127], v5, s[28:31], s75 offen offset:3072 nt
  s_add_u32 s99, s74, 8192
  s_and_b32 s99, s99, 0xffff
  s_and_b32 s74, s74, 0xffff0000
  s_or_b32 s74, s74, s99
  s_add_u32 s75, s74, 4096
  buffer_load_dwordx4 v[128:131], v5, s[28:31], s74 offen offset:0 nt
  buffer_load_dwordx4 v[132:135], v5, s[28:31], s74 offen offset:1024 nt
  buffer_load_dwordx4 v[136:139], v5, s[28:31], s74 offen offset:2048 nt
  buffer_load_dwordx4 v[140:143], v5, s[28:31], s74 offen offset:3072 nt
  buffer_load_dwordx4 v[144:147], v5, s[28:31], s75 offen offset:0 nt
  buffer_load_dwordx4 v[148:151], v5, s[28:31], s75 offen offset:1024 nt
  buffer_load_dwordx4 v[152:155], v5, s[28:31], s75 offen offset:2048 nt
  buffer_load_dwordx4 v[156:159], v5, s[28:31], s75 offen offset:3072 nt
  s_add_u32 s99, s74, 8192
  s_and_b32 s99, s99, 0xffff
  s_and_b32 s74, s74, 0xffff0000
  s_or_b32 s74, s74, s99
  s_add_u32 s75, s74, 4096
  buffer_load_dwordx4 v[160:163], v5, s[28:31], s74 offen offset:0 nt
  buffer_load_dwordx4 v[164:167], v5, s[28:31], s74 offen offset:1024 nt
  buffer_load_dwordx4 v[168:171], v5, s[28:31], s74 offen offset:2048 nt
  buffer_load_dwordx4 v[172:175], v5, s[28:31], s74 offen offset:3072 nt
  buffer_load_dwordx4 v[176:179], v5, s[28:31], s75 offen offset:0 nt
  buffer_load_dwordx4 v[180:183], v5, s[28:31], s75 offen offset:1024 nt
  buffer_load_dwordx4 v[184:187], v5, s[28:31], s75 offen offset:2048 nt
  buffer_load_dwordx4 v[188:191], v5, s[28:31], s75 offen offset:3072 nt
  s_add_u32 s99, s74, 8192
  s_and_b32 s99, s99, 0xffff
  s_and_b32 s74, s74, 0xffff0000
  s_or_b32 s74, s74, s99
  s_add_u32 s75, s74, 4096
L_join:
  s_mov_b32 s65, 0
  s_mov_b32 s66, 0
  s_mov_b32 s67, 0
  s_lshr_b32 s68, s2, 3
  s_and_b32 s84, s2, 7
  s_sub_u32 s85, s84, s68
  s_and_b32 s85, s85, 7
  s_mov_b32 s48, s12
  s_mov_b32 s49, s13
  s_mov_b32 s50, 0x400000
  s_mov_b32 s51, 0x00020000
  s_cmp_eq_u32 s85, 0
  s_cbranch_scc1 L_role_wo
  s_cmp_eq_u32 s85, 5
  s_cbranch_scc1 L_role_fin
  s_cmp_lg_u32 s85, 3
  s_cbranch_scc1 L_norole
  s_cmp_ge_u32 s68, 14
  s_cbranch_scc1 L_norole
  s_mov_b32 s48, s20
  s_mov_b32 s49, s21
  s_mov_b32 s50, 0x1c0000
  s_mov_b32 s51, 0x00020000
  s_mov_b32 s65, 2
  s_branch L_role_w
L_role_wo:
  s_mov_b32 s65, 1
L_role_w:
  s_lshl_b32 s84, s68, 7
  s_and_b32 s85, s60, 1
  s_lshl_b32 s85, s85, 2
  s_add_u32 s84, s84, s85
  s_lshl_b32 s84, s84, 10
  s_lshr_b32 s85, s60, 1
  s_lshl_b32 s85, s85, 8
  s_add_u32 s66, s84, s85
  s_add_u32 s67, s66, 2048
  s_branch L_roledone
L_role_fin:
  s_mov_b32 s65, 3
L_norole:
  s_mov_b32 s50, 0
L_roledone:
  v_and_b32 v7, 1, v4
  v_lshlrev_b32 v7, 6, v7
  v_lshrrev_b32 v8, 1, v4
  v_add_u32 v7, v7, v8
  v_lshlrev_b32 v7, 10, v7
  v_lshl_add_u32 v7, v3, 4, v7
  s_barrier
  v_and_b32 v9, 3, v3
  v_lshlrev_b32 v9, 8, v9
  v_lshrrev_b32 v10, 2, v3
  v_lshl_add_u32 v9, v10, 6, v9
  v_lshl_add_u32 v9, v4, 4, v9
  ds_read_b128 v[192:195], v9 offset:33024
  v_mov_b32 v12, 0xff800000
  s_waitcnt lgkmcnt(0)
  s_waitcnt vmcnt(24)
  v_mfma_f32_16x16x32_bf16 v[16:19], v[64:67], v[192:195], 0
  v_mfma_f32_16x16x32_bf16 v[20:23], v[68:71], v[192:195], 0
  v_mfma_f32_16x16x32_bf16 v[24:27], v[72:75], v[192:195], 0
  v_mfma_f32_16x16x32_bf16 v[28:31], v[76:79], v[192:195], 0
  v_mfma_f32_16x16x32_bf16 v[196:199], v[80:83], v[192:195], 0
  v_mfma_f32_16x16x32_bf16 v[200:203], v[84:87], v[192:195], 0
  v_mfma_f32_16x16x32_bf16 v[204:207], v[88:91], v[192:195], 0
  v_mfma_f32_16x16x32_bf16 v[208:211], v[92:95], v[192:195], 0
  buffer_load_dwordx4 v[64:67], v5, s[28:31], s74 offen offset:0 nt
  buffer_load_dwordx4 v[68:71], v5, s[28:31], s74 offen offset:1024 nt
  buffer_load_dwordx4 v[72:75], v5, s[28:31], s74 offen offset:2048 nt
  buffer_load_dwordx4 v[76:79], v5, s[28:31], s74 offen offset:3072 nt
  buffer_load_dwordx4 v[80:83], v5, s[28:31], s75 offen offset:0 nt
  buffer_load_dwordx4 v[84:87], v5, s[28:31], s75 offen offset:1024 nt
  buffer_load_dwordx4 v[88:91], v5, s[28:31], s75 offen offset:2048 nt
  buffer_load_dwordx4 v[92:95], v5, s[28:31], s75 offen offset:3072 nt
  s_add_u32 s99, s74, 8192
  s_and_b32 s99, s99, 0xffff
  s_and_b32 s74, s74, 0xffff0000
  s_or_b32 s74, s74, s99
  s_add_u32 s75, s74, 4096
  v_add_f32_dpp v212, v17, v16 row_shl:4 row_mask:0xf bank_mask:0xf bound_ctrl:0
  v_add_f32_dpp v213, v21, v20 row_shl:4 row_mask:0xf bank_mask:0xf bound_ctrl:0
  v_add_f32_dpp v214, v25, v24 row_shl:4 row_mask:0xf bank_mask:0xf bound_ctrl:0
  v_add_f32_dpp v215, v29, v28 row_shl:4 row_mask:0xf bank_mask:0xf bound_ctrl:0
  v_add_f32_dpp v216, v197, v196 row_shl:4 row_mask:0xf bank_mask:0xf bound_ctrl:0
  v_add_f32_dpp v217, v201, v200 row_shl:4 row_mask:0xf bank_mask:0xf bound_ctrl:0
  v_add_f32_dpp v218, v205, v204 row_shl:4 row_mask:0xf bank_mask:0xf bound_ctrl:0
  v_add_f32_dpp v219, v209, v208 row_shl:4 row_mask:0xf bank_mask:0xf bound_ctrl:0
  v_add_f32_dpp v212, v18, v212 row_shl:8 row_mask:0xf bank_mask:0xf bound_ctrl:0
  v_add_f32_dpp v213, v22, v213 row_shl:8 row_mask:0xf bank_mask:0xf bound_ctrl:0
  v_add_f32_dpp v214, v26, v214 row_shl:8 row_mask:0xf bank_mask:0xf bound_ctrl:0
  v_add_f32_dpp v215, v30, v215 row_shl:8 row_mask:0xf bank_mask:0xf bound_ctrl:0
  v_add_f32_dpp v216, v198, v216 row_shl:8 row_mask:0xf bank_mask:0xf bound_ctrl:0
  v_add_f32_dpp v217, v202, v217 row_shl:8 row_mask:0xf bank_mask:0xf bound_ctrl:0
  v_add_f32_dpp v218, v206, v218 row_shl:8 row_mask:0xf bank_mask:0xf bound_ctrl:0
  v_add_f32_dpp v219, v210, v219 row_shl:8 row_mask:0xf bank_mask:0xf bound_ctrl:0
  v_add_f32_dpp v212, v19, v212 row_shl:12 row_mask:0xf bank_mask:0xf bound_ctrl:0
  v_add_f32_dpp v213, v23, v213 row_shl:12 row_mask:0xf bank_mask:0xf bound_ctrl:0
  v_add_f32_dpp v214, v27, v214 row_shl:12 row_mask:0xf bank_mask:0xf bound_ctrl:0
  v_add_f32_dpp v215, v31, v215 row_shl:12 row_mask:0xf bank_mask:0xf bound_ctrl:0
  v_add_f32_dpp v216, v199, v216 row_shl:12 row_mask:0xf bank_mask:0xf bound_ctrl:0
  v_add_f32_dpp v217, v203, v217 row_shl:12 row_mask:0xf bank_mask:0xf bound_ctrl:0
  v_add_f32_dpp v218, v207, v218 row_shl:12 row_mask:0xf bank_mask:0xf bound_ctrl:0
  v_add_f32_dpp v219, v211, v219 row_shl:12 row_mask:0xf bank_mask:0xf bound_ctrl:0
  v_cvt_pk_bf16_f32 v16, v212, v213
  v_cvt_pk_bf16_f32 v17, v214, v215
  v_cvt_pk_bf16_f32 v18, v216, v217
  v_cvt_pk_bf16_f32 v19, v218, v219
  v_lshlrev_b32 v212, 16, v16
  v_and_b32 v213, 0xffff0000, v16
  v_lshlrev_b32 v214, 16, v17
  v_and_b32 v215, 0xffff0000, v17
  v_lshlrev_b32 v216, 16, v18
  v_and_b32 v217, 0xffff0000, v18
  v_lshlrev_b32 v218, 16, v19
  v_and_b32 v219, 0xffff0000, v19
  v_mul_f32 v212, s72, v212
  v_mul_f32 v213, s72, v213
  v_mul_f32 v214, s72, v214
  v_mul_f32 v215, s72, v215
  v_mul_f32 v216, s72, v216
  v_mul_f32 v217, s72, v217
  v_mul_f32 v218, s72, v218
  v_mul_f32 v219, s72, v219
  v_cvt_pk_bf16_f32 v32, v212, v213
  v_cvt_pk_bf16_f32 v33, v214, v215
  v_cvt_pk_bf16_f32 v34, v216, v217
  v_cvt_pk_bf16_f32 v35, v218, v219
  v_max3_f32 v12, v212, v213, v12
  v_max3_f32 v12, v214, v215, v12
  v_max3_f32 v12, v216, v217, v12
  v_max3_f32 v12, v218, v219, v12
  s_waitcnt vmcnt(24)
  v_mfma_f32_16x16x32_bf16 v[16:19], v[96:99], v[192:195], 0
  v_mfma_f32_16x16x32_bf16 v[20:23], v[100:103], v[192:195], 0
  v_mfma_f32_16x16x32_bf16 v[24:27], v[104:107], v[192:195], 0
  v_mfma_f32_16x16x32_bf16 v[28:31], v[108:111], v[192:195], 0
  v_mfma_f32_16x16x32_bf16 v[196:199], v[112:115], v[192:195], 0
  v_mfma_f32_16x16x32_bf16 v[200:203], v[116:119], v[192:195], 0
  v_mfma_f32_16x16x32_bf16 v[204:207], v[120:123], v[192:195], 0
  v_mfma_f32_16x16x32_bf16 v[208:211], v[124:127], v[192:195], 0
  buffer_load_dwordx4 v[96:99], v5, s[28:31], s74 offen offset:0 nt
  buffer_load_dwordx4 v[100:103], v5, s[28:31], s74 offen offset:1024 nt
  buffer_load_dwordx4 v[104:107], v5, s[28:31], s74 offen offset:2048 nt
  buffer_load_dwordx4 v[108:111], v5, s[28:31], s74 offen offset:3072 nt
  buffer_load_dwordx4 v[112:115], v5, s[28:31], s75 offen offset:0 nt
  buffer_load_dwordx4 v[116:119], v5, s[28:31], s75 offen offset:1024 nt
  buffer_load_dwordx4 v[120:123], v5, s[28:31], s75 offen offset:2048 nt
  buffer_load_dwordx4 v[124:127], v5, s[28:31], s75 offen offset:3072 nt
  s_add_u32 s99, s74, 8192
  s_and_b32 s99, s99, 0xffff
  s_and_b32 s74, s74, 0xffff0000
  s_or_b32 s74, s74, s99
  s_add_u32 s75, s74, 4096
  v_add_f32_dpp v212, v17, v16 row_shl:4 row_mask:0xf bank_mask:0xf bound_ctrl:0
  v_add_f32_dpp v213, v21, v20 row_shl:4 row_mask:0xf bank_mask:0xf bound_ctrl:0
  v_add_f32_dpp v214, v25, v24 row_shl:4 row_mask:0xf bank_mask:0xf bound_ctrl:0
  v_add_f32_dpp v215, v29, v28 row_shl:4 row_mask:0xf bank_mask:0xf bound_ctrl:0
  v_add_f32_dpp v216, v197, v196 row_shl:4 row_mask:0xf bank_mask:0xf bound_ctrl:0
  v_add_f32_dpp v217, v201, v200 row_shl:4 row_mask:0xf bank_mask:0xf bound_ctrl:0
  v_add_f32_dpp v218, v205, v204 row_shl:4 row_mask:0xf bank_mask:0xf bound_ctrl:0
  v_add_f32_dpp v219, v209, v208 row_shl:4 row_mask:0xf bank_mask:0xf bound_ctrl:0
  v_add_f32_dpp v212, v18, v212 row_shl:8 row_mask:0xf bank_mask:0xf bound_ctrl:0
  v_add_f32_dpp v213, v22, v213 row_shl:8 row_mask:0xf bank_mask:0xf bound_ctrl:0
  v_add_f32_dpp v214, v26, v214 row_shl:8 row_mask:0xf bank_mask:0xf bound_ctrl:0
  v_add_f32_dpp v215, v30, v215 row_shl:8 row_mask:0xf bank_mask:0xf bound_ctrl:0
  v_add_f32_dpp v216, v198, v216 row_shl:8 row_mask:0xf bank_mask:0xf bound_ctrl:0
  v_add_f32_dpp v217, v202, v217 row_shl:8 row_mask:0xf bank_mask:0xf bound_ctrl:0
  v_add_f32_dpp v218, v206, v218 row_shl:8 row_mask:0xf bank_mask:0xf bound_ctrl:0
  v_add_f32_dpp v219, v210, v219 row_shl:8 row_mask:0xf bank_mask:0xf bound_ctrl:0
  v_add_f32_dpp v212, v19, v212 row_shl:12 row_mask:0xf bank_mask:0xf bound_ctrl:0
  v_add_f32_dpp v213, v23, v213 row_shl:12 row_mask:0xf bank_mask:0xf bound_ctrl:0
  v_add_f32_dpp v214, v27, v214 row_shl:12 row_mask:0xf bank_mask:0xf bound_ctrl:0
  v_add_f32_dpp v215, v31, v215 row_shl:12 row_mask:0xf bank_mask:0xf bound_ctrl:0
  v_add_f32_dpp v216, v199, v216 row_shl:12 row_mask:0xf bank_mask:0xf bound_ctrl:0
  v_add_f32_dpp v217, v203, v217 row_shl:12 row_mask:0xf bank_mask:0xf bound_ctrl:0
  v_add_f32_dpp v218, v207, v218 row_shl:12 row_mask:0xf bank_mask:0xf bound_ctrl:0
  v_add_f32_dpp v219, v211, v219 row_shl:12 row_mask:0xf bank_mask:0xf bound_ctrl:0
  v_cvt_pk_bf16_f32 v16, v212, v213
  v_cvt_pk_bf16_f32 v17, v214, v215
  v_cvt_pk_bf16_f32 v18, v216, v217
  v_cvt_pk_bf16_f32 v19, v218, v219
  v_lshlrev_b32 v212, 16, v16
  v_and_b32 v213, 0xffff0000, v16
  v_lshlrev_b32 v214, 16, v17
  v_and_b32 v215, 0xffff0000, v17
  v_lshlrev_b32 v216, 16, v18
  v_and_b32 v217, 0xffff0000, v18
  v_lshlrev_b32 v218, 16, v19
  v_and_b32 v219, 0xffff0000, v19
  v_mul_f32 v212, s72, v212
  v_mul_f32 v213, s72, v213
  v_mul_f32 v214, s72, v214
  v_mul_f32 v215, s72, v215
  v_mul_f32 v216, s72, v216
  v_mul_f32 v217, s72, v217
  v_mul_f32 v218, s72, v218
  v_mul_f32 v219, s72, v219
  v_cvt_pk_bf16_f32 v36, v212, v213
  v_cvt_pk_bf16_f32 v37, v214, v215
  v_cvt_pk_bf16_f32 v38, v216, v217
  v_cvt_pk_bf16_f32 v39, v218, v219
  v_max3_f32 v12, v212, v213, v12
  v_max3_f32 v12, v214, v215, v12
  v_max3_f32 v12, v216, v217, v12
  v_max3_f32 v12, v218, v219, v12
  s_waitcnt vmcnt(24)
  v_mfma_f32_16x16x32_bf16 v[16:19], v[128:131], v[192:195], 0
  v_mfma_f32_16x16x32_bf16 v[20:23], v[132:135], v[192:195], 0
  v_mfma_f32_16x16x32_bf16 v[24:27], v[136:139], v[192:195], 0
  v_mfma_f32_16x16x32_bf16 v[28:31], v[140:143], v[192:195], 0
  v_mfma_f32_16x16x32_bf16 v[196:199], v[144:147], v[192:195], 0
  v_mfma_f32_16x16x32_bf16 v[200:203], v[148:151], v[192:195], 0
  v_mfma_f32_16x16x32_bf16 v[204:207], v[152:155], v[192:195], 0
  v_mfma_f32_16x16x32_bf16 v[208:211], v[156:159], v[192:195], 0
  buffer_load_dwordx4 v[128:131], v5, s[28:31], s74 offen offset:0 nt
  buffer_load_dwordx4 v[132:135], v5, s[28:31], s74 offen offset:1024 nt
  buffer_load_dwordx4 v[136:139], v5, s[28:31], s74 offen offset:2048 nt
  buffer_load_dwordx4 v[140:143], v5, s[28:31], s74 offen offset:3072 nt
  buffer_load_dwordx4 v[144:147], v5, s[28:31], s75 offen offset:0 nt
  buffer_load_dwordx4 v[148:151], v5, s[28:31], s75 offen offset:1024 nt
  buffer_load_dwordx4 v[152:155], v5, s[28:31], s75 offen offset:2048 nt
  buffer_load_dwordx4 v[156:159], v5, s[28:31], s75 offen offset:3072 nt
  s_add_u32 s99, s74, 8192
  s_and_b32 s99, s99, 0xffff
  s_and_b32 s74, s74, 0xffff0000
  s_or_b32 s74, s74, s99
  s_add_u32 s75, s74, 4096
  v_add_f32_dpp v212, v17, v16 row_shl:4 row_mask:0xf bank_mask:0xf bound_ctrl:0
  v_add_f32_dpp v213, v21, v20 row_shl:4 row_mask:0xf bank_mask:0xf bound_ctrl:0
  v_add_f32_dpp v214, v25, v24 row_shl:4 row_mask:0xf bank_mask:0xf bound_ctrl:0
  v_add_f32_dpp v215, v29, v28 row_shl:4 row_mask:0xf bank_mask:0xf bound_ctrl:0
  v_add_f32_dpp v216, v197, v196 row_shl:4 row_mask:0xf bank_mask:0xf bound_ctrl:0
  v_add_f32_dpp v217, v201, v200 row_shl:4 row_mask:0xf bank_mask:0xf bound_ctrl:0
  v_add_f32_dpp v218, v205, v204 row_shl:4 row_mask:0xf bank_mask:0xf bound_ctrl:0
  v_add_f32_dpp v219, v209, v208 row_shl:4 row_mask:0xf bank_mask:0xf bound_ctrl:0
  v_add_f32_dpp v212, v18, v212 row_shl:8 row_mask:0xf bank_mask:0xf bound_ctrl:0
  v_add_f32_dpp v213, v22, v213 row_shl:8 row_mask:0xf bank_mask:0xf bound_ctrl:0
  v_add_f32_dpp v214, v26, v214 row_shl:8 row_mask:0xf bank_mask:0xf bound_ctrl:0
  v_add_f32_dpp v215, v30, v215 row_shl:8 row_mask:0xf bank_mask:0xf bound_ctrl:0
  v_add_f32_dpp v216, v198, v216 row_shl:8 row_mask:0xf bank_mask:0xf bound_ctrl:0
  v_add_f32_dpp v217, v202, v217 row_shl:8 row_mask:0xf bank_mask:0xf bound_ctrl:0
  v_add_f32_dpp v218, v206, v218 row_shl:8 row_mask:0xf bank_mask:0xf bound_ctrl:0
  v_add_f32_dpp v219, v210, v219 row_shl:8 row_mask:0xf bank_mask:0xf bound_ctrl:0
  v_add_f32_dpp v212, v19, v212 row_shl:12 row_mask:0xf bank_mask:0xf bound_ctrl:0
  v_add_f32_dpp v213, v23, v213 row_shl:12 row_mask:0xf bank_mask:0xf bound_ctrl:0
  v_add_f32_dpp v214, v27, v214 row_shl:12 row_mask:0xf bank_mask:0xf bound_ctrl:0
  v_add_f32_dpp v215, v31, v215 row_shl:12 row_mask:0xf bank_mask:0xf bound_ctrl:0
  v_add_f32_dpp v216, v199, v216 row_shl:12 row_mask:0xf bank_mask:0xf bound_ctrl:0
  v_add_f32_dpp v217, v203, v217 row_shl:12 row_mask:0xf bank_mask:0xf bound_ctrl:0
  v_add_f32_dpp v218, v207, v218 row_shl:12 row_mask:0xf bank_mask:0xf bound_ctrl:0
  v_add_f32_dpp v219, v211, v219 row_shl:12 row_mask:0xf bank_mask:0xf bound_ctrl:0
  v_cvt_pk_bf16_f32 v16, v212, v213
  v_cvt_pk_bf16_f32 v17, v214, v215
  v_cvt_pk_bf16_f32 v18, v216, v217
  v_cvt_pk_bf16_f32 v19, v218, v219
  v_lshlrev_b32 v212, 16, v16
  v_and_b32 v213, 0xffff0000, v16
  v_lshlrev_b32 v214, 16, v17
  v_and_b32 v215, 0xffff0000, v17
  v_lshlrev_b32 v216, 16, v18
  v_and_b32 v217, 0xffff0000, v18
  v_lshlrev_b32 v218, 16, v19
  v_and_b32 v219, 0xffff0000, v19
  v_mul_f32 v212, s72, v212
  v_mul_f32 v213, s72, v213
  v_mul_f32 v214, s72, v214
  v_mul_f32 v215, s72, v215
  v_mul_f32 v216, s72, v216
  v_mul_f32 v217, s72, v217
  v_mul_f32 v218, s72, v218
  v_mul_f32 v219, s72, v219
  v_cvt_pk_bf16_f32 v40, v212, v213
  v_cvt_pk_bf16_f32 v41, v214, v215
  v_cvt_pk_bf16_f32 v42, v216, v217
  v_cvt_pk_bf16_f32 v43, v218, v219
  v_max3_f32 v12, v212, v213, v12
  v_max3_f32 v12, v214, v215, v12
  v_max3_f32 v12, v216, v217, v12
  v_max3_f32 v12, v218, v219, v12
  s_waitcnt vmcnt(24)
  v_mfma_f32_16x16x32_bf16 v[16:19], v[160:163], v[192:195], 0
  v_mfma_f32_16x16x32_bf16 v[20:23], v[164:167], v[192:195], 0
  v_mfma_f32_16x16x32_bf16 v[24:27], v[168:171], v[192:195], 0
  v_mfma_f32_16x16x32_bf16 v[28:31], v[172:175], v[192:195], 0
  v_mfma_f32_16x16x32_bf16 v[196:199], v[176:179], v[192:195], 0
  v_mfma_f32_16x16x32_bf16 v[200:203], v[180:183], v[192:195], 0
  v_mfma_f32_16x16x32_bf16 v[204:207], v[184:187], v[192:195], 0
  v_mfma_f32_16x16x32_bf16 v[208:211], v[188:191], v[192:195], 0
  buffer_load_dwordx4 v[160:163], v5, s[28:31], s74 offen offset:0 nt
  buffer_load_dwordx4 v[164:167], v5, s[28:31], s74 offen offset:1024 nt
  buffer_load_dwordx4 v[168:171], v5, s[28:31], s74 offen offset:2048 nt
  buffer_load_dwordx4 v[172:175], v5, s[28:31], s74 offen offset:3072 nt
  buffer_load_dwordx4 v[176:179], v5, s[28:31], s75 offen offset:0 nt
  buffer_load_dwordx4 v[180:183], v5, s[28:31], s75 offen offset:1024 nt
  buffer_load_dwordx4 v[184:187], v5, s[28:31], s75 offen offset:2048 nt
  buffer_load_dwordx4 v[188:191], v5, s[28:31], s75 offen offset:3072 nt
  s_add_u32 s99, s74, 8192
  s_and_b32 s99, s99, 0xffff
  s_and_b32 s74, s74, 0xffff0000
  s_or_b32 s74, s74, s99
  s_add_u32 s75, s74, 4096
  v_add_f32_dpp v212, v17, v16 row_shl:4 row_mask:0xf bank_mask:0xf bound_ctrl:0
  v_add_f32_dpp v213, v21, v20 row_shl:4 row_mask:0xf bank_mask:0xf bound_ctrl:0
  v_add_f32_dpp v214, v25, v24 row_shl:4 row_mask:0xf bank_mask:0xf bound_ctrl:0
  v_add_f32_dpp v215, v29, v28 row_shl:4 row_mask:0xf bank_mask:0xf bound_ctrl:0
  v_add_f32_dpp v216, v197, v196 row_shl:4 row_mask:0xf bank_mask:0xf bound_ctrl:0
  v_add_f32_dpp v217, v201, v200 row_shl:4 row_mask:0xf bank_mask:0xf bound_ctrl:0
  v_add_f32_dpp v218, v205, v204 row_shl:4 row_mask:0xf bank_mask:0xf bound_ctrl:0
  v_add_f32_dpp v219, v209, v208 row_shl:4 row_mask:0xf bank_mask:0xf bound_ctrl:0
  v_add_f32_dpp v212, v18, v212 row_shl:8 row_mask:0xf bank_mask:0xf bound_ctrl:0
  v_add_f32_dpp v213, v22, v213 row_shl:8 row_mask:0xf bank_mask:0xf bound_ctrl:0
  v_add_f32_dpp v214, v26, v214 row_shl:8 row_mask:0xf bank_mask:0xf bound_ctrl:0
  v_add_f32_dpp v215, v30, v215 row_shl:8 row_mask:0xf bank_mask:0xf bound_ctrl:0
  v_add_f32_dpp v216, v198, v216 row_shl:8 row_mask:0xf bank_mask:0xf bound_ctrl:0
  v_add_f32_dpp v217, v202, v217 row_shl:8 row_mask:0xf bank_mask:0xf bound_ctrl:0
  v_add_f32_dpp v218, v206, v218 row_shl:8 row_mask:0xf bank_mask:0xf bound_ctrl:0
  v_add_f32_dpp v219, v210, v219 row_shl:8 row_mask:0xf bank_mask:0xf bound_ctrl:0
  v_add_f32_dpp v212, v19, v212 row_shl:12 row_mask:0xf bank_mask:0xf bound_ctrl:0
  v_add_f32_dpp v213, v23, v213 row_shl:12 row_mask:0xf bank_mask:0xf bound_ctrl:0
  v_add_f32_dpp v214, v27, v214 row_shl:12 row_mask:0xf bank_mask:0xf bound_ctrl:0
  v_add_f32_dpp v215, v31, v215 row_shl:12 row_mask:0xf bank_mask:0xf bound_ctrl:0
  v_add_f32_dpp v216, v199, v216 row_shl:12 row_mask:0xf bank_mask:0xf bound_ctrl:0
  v_add_f32_dpp v217, v203, v217 row_shl:12 row_mask:0xf bank_mask:0xf bound_ctrl:0
  v_add_f32_dpp v218, v207, v218 row_shl:12 row_mask:0xf bank_mask:0xf bound_ctrl:0
  v_add_f32_dpp v219, v211, v219 row_shl:12 row_mask:0xf bank_mask:0xf bound_ctrl:0
  v_cvt_pk_bf16_f32 v16, v212, v213
  v_cvt_pk_bf16_f32 v17, v214, v215
  v_cvt_pk_bf16_f32 v18, v216, v217
  v_cvt_pk_bf16_f32 v19, v218, v219
  v_lshlrev_b32 v212, 16, v16
  v_and_b32 v213, 0xffff0000, v16
  v_lshlrev_b32 v214, 16, v17
  v_and_b32 v215, 0xffff0000, v17
  v_lshlrev_b32 v216, 16, v18
  v_and_b32 v217, 0xffff0000, v18
  v_lshlrev_b32 v218, 16, v19
  v_and_b32 v219, 0xffff0000, v19
  v_mul_f32 v212, s72, v212
  v_mul_f32 v213, s72, v213
  v_mul_f32 v214, s72, v214
  v_mul_f32 v215, s72, v215
  v_mul_f32 v216, s72, v216
  v_mul_f32 v217, s72, v217
  v_mul_f32 v218, s72, v218
  v_mul_f32 v219, s72, v219
  v_cvt_pk_bf16_f32 v44, v212, v213
  v_cvt_pk_bf16_f32 v45, v214, v215
  v_cvt_pk_bf16_f32 v46, v216, v217
  v_cvt_pk_bf16_f32 v47, v218, v219
  v_max3_f32 v12, v212, v213, v12
  v_max3_f32 v12, v214, v215, v12
  v_max3_f32 v12, v216, v217, v12
  v_max3_f32 v12, v218, v219, v12
  s_waitcnt vmcnt(24)
  v_mfma_f32_16x16x32_bf16 v[16:19], v[64:67], v[192:195], 0
  v_mfma_f32_16x16x32_bf16 v[20:23], v[68:71], v[192:195], 0
  v_mfma_f32_16x16x32_bf16 v[24:27], v[72:75], v[192:195], 0
  v_mfma_f32_16x16x32_bf16 v[28:31], v[76:79], v[192:195], 0
  v_mfma_f32_16x16x32_bf16 v[196:199], v[80:83], v[192:195], 0
  v_mfma_f32_16x16x32_bf16 v[200:203], v[84:87], v[192:195], 0
  v_mfma_f32_16x16x32_bf16 v[204:207], v[88:91], v[192:195], 0
  v_mfma_f32_16x16x32_bf16 v[208:211], v[92:95], v[192:195], 0
  buffer_load_dwordx4 v[64:67], v6, s[32:35], s76 offen offset:0 nt
  buffer_load_dwordx4 v[68:71], v6, s[32:35], s76 offen offset:1024 nt
  buffer_load_dwordx4 v[72:75], v6, s[32:35], s76 offen offset:2048 nt
  buffer_load_dwordx4 v[76:79], v6, s[32:35], s76 offen offset:3072 nt
  buffer_load_dwordx4 v[80:83], v6, s[32:35], s77 offen offset:0 nt
  buffer_load_dwordx4 v[84:87], v6, s[32:35], s77 offen offset:1024 nt
  buffer_load_dwordx4 v[88:91], v6, s[32:35], s77 offen offset:2048 nt
  buffer_load_dwordx4 v[92:95], v6, s[32:35], s77 offen offset:3072 nt
  s_add_u32 s99, s76, 8192
  s_and_b32 s99, s99, 0xffff
  s_and_b32 s76, s76, 0xffff0000
  s_or_b32 s76, s76, s99
  s_add_u32 s77, s76, 4096
  v_add_f32_dpp v212, v17, v16 row_shl:4 row_mask:0xf bank_mask:0xf bound_ctrl:0
  v_add_f32_dpp v213, v21, v20 row_shl:4 row_mask:0xf bank_mask:0xf bound_ctrl:0
  v_add_f32_dpp v214, v25, v24 row_shl:4 row_mask:0xf bank_mask:0xf bound_ctrl:0
  v_add_f32_dpp v215, v29, v28 row_shl:4 row_mask:0xf bank_mask:0xf bound_ctrl:0
  v_add_f32_dpp v216, v197, v196 row_shl:4 row_mask:0xf bank_mask:0xf bound_ctrl:0
  v_add_f32_dpp v217, v201, v200 row_shl:4 row_mask:0xf bank_mask:0xf bound_ctrl:0
  v_add_f32_dpp v218, v205, v204 row_shl:4 row_mask:0xf bank_mask:0xf bound_ctrl:0
  v_add_f32_dpp v219, v209, v208 row_shl:4 row_mask:0xf bank_mask:0xf bound_ctrl:0
  v_add_f32_dpp v212, v18, v212 row_shl:8 row_mask:0xf bank_mask:0xf bound_ctrl:0
  v_add_f32_dpp v213, v22, v213 row_shl:8 row_mask:0xf bank_mask:0xf bound_ctrl:0
  v_add_f32_dpp v214, v26, v214 row_shl:8 row_mask:0xf bank_mask:0xf bound_ctrl:0
  v_add_f32_dpp v215, v30, v215 row_shl:8 row_mask:0xf bank_mask:0xf bound_ctrl:0
  v_add_f32_dpp v216, v198, v216 row_shl:8 row_mask:0xf bank_mask:0xf bound_ctrl:0
  v_add_f32_dpp v217, v202, v217 row_shl:8 row_mask:0xf bank_mask:0xf bound_ctrl:0
  v_add_f32_dpp v218, v206, v218 row_shl:8 row_mask:0xf bank_mask:0xf bound_ctrl:0
  v_add_f32_dpp v219, v210, v219 row_shl:8 row_mask:0xf bank_mask:0xf bound_ctrl:0
  v_add_f32_dpp v212, v19, v212 row_shl:12 row_mask:0xf bank_mask:0xf bound_ctrl:0
  v_add_f32_dpp v213, v23, v213 row_shl:12 row_mask:0xf bank_mask:0xf bound_ctrl:0
  v_add_f32_dpp v214, v27, v214 row_shl:12 row_mask:0xf bank_mask:0xf bound_ctrl:0
  v_add_f32_dpp v215, v31, v215 row_shl:12 row_mask:0xf bank_mask:0xf bound_ctrl:0
  v_add_f32_dpp v216, v199, v216 row_shl:12 row_mask:0xf bank_mask:0xf bound_ctrl:0
  v_add_f32_dpp v217, v203, v217 row_shl:12 row_mask:0xf bank_mask:0xf bound_ctrl:0
  v_add_f32_dpp v218, v207, v218 row_shl:12 row_mask:0xf bank_mask:0xf bound_ctrl:0
  v_add_f32_dpp v219, v211, v219 row_shl:12 row_mask:0xf bank_mask:0xf bound_ctrl:0
  v_cvt_pk_bf16_f32 v16, v212, v213
  v_cvt_pk_bf16_f32 v17, v214, v215
  v_cvt_pk_bf16_f32 v18, v216, v217
  v_cvt_pk_bf16_f32 v19, v218, v219
  v_lshlrev_b32 v212, 16, v16
  v_and_b32 v213, 0xffff0000, v16
  v_lshlrev_b32 v214, 16, v17
  v_and_b32 v215, 0xffff0000, v17
  v_lshlrev_b32 v216, 16, v18
  v_and_b32 v217, 0xffff0000, v18
  v_lshlrev_b32 v218, 16, v19
  v_and_b32 v219, 0xffff0000, v19
  v_mul_f32 v212, s72, v212
  v_mul_f32 v213, s72, v213
  v_mul_f32 v214, s72, v214
  v_mul_f32 v215, s72, v215
  v_mul_f32 v216, s72, v216
  v_mul_f32 v217, s72, v217
  v_mul_f32 v218, s72, v218
  v_mul_f32 v219, s72, v219
  v_cvt_pk_bf16_f32 v48, v212, v213
  v_cvt_pk_bf16_f32 v49, v214, v215
  v_cvt_pk_bf16_f32 v50, v216, v217
  v_cvt_pk_bf16_f32 v51, v218, v219
  v_max3_f32 v12, v212, v213, v12
  v_max3_f32 v12, v214, v215, v12
  v_max3_f32 v12, v216, v217, v12
  v_max3_f32 v12, v218, v219, v12
  s_waitcnt vmcnt(24)
  v_mfma_f32_16x16x32_bf16 v[16:19], v[96:99], v[192:195], 0
  v_mfma_f32_16x16x32_bf16 v[20:23], v[100:103], v[192:195], 0
  v_mfma_f32_16x16x32_bf16 v[24:27], v[104:107], v[192:195], 0
  v_mfma_f32_16x16x32_bf16 v[28:31], v[108:111], v[192:195], 0
  v_mfma_f32_16x16x32_bf16 v[196:199], v[112:115], v[192:195], 0
  v_mfma_f32_16x16x32_bf16 v[200:203], v[116:119], v[192:195], 0
  v_mfma_f32_16x16x32_bf16 v[204:207], v[120:123], v[192:195], 0
  v_mfma_f32_16x16x32_bf16 v[208:211], v[124:127], v[192:195], 0
  buffer_load_dwordx4 v[96:99], v6, s[32:35], s76 offen offset:0 nt
  buffer_load_dwordx4 v[100:103], v6, s[32:35], s76 offen offset:1024 nt
  buffer_load_dwordx4 v[104:107], v6, s[32:35], s76 offen offset:2048 nt
  buffer_load_dwordx4 v[108:111], v6, s[32:35], s76 offen offset:3072 nt
  buffer_load_dwordx4 v[112:115], v6, s[32:35], s77 offen offset:0 nt
  buffer_load_dwordx4 v[116:119], v6, s[32:35], s77 offen offset:1024 nt
  buffer_load_dwordx4 v[120:123], v6, s[32:35], s77 offen offset:2048 nt
  buffer_load_dwordx4 v[124:127], v6, s[32:35], s77 offen offset:3072 nt
  s_add_u32 s99, s76, 8192
  s_and_b32 s99, s99, 0xffff
  s_and_b32 s76, s76, 0xffff0000
  s_or_b32 s76, s76, s99
  s_add_u32 s77, s76, 4096
  v_add_f32_dpp v212, v17, v16 row_shl:4 row_mask:0xf bank_mask:0xf bound_ctrl:0
  v_add_f32_dpp v213, v21, v20 row_shl:4 row_mask:0xf bank_mask:0xf bound_ctrl:0
  v_add_f32_dpp v214, v25, v24 row_shl:4 row_mask:0xf bank_mask:0xf bound_ctrl:0
  v_add_f32_dpp v215, v29, v28 row_shl:4 row_mask:0xf bank_mask:0xf bound_ctrl:0
  v_add_f32_dpp v216, v197, v196 row_shl:4 row_mask:0xf bank_mask:0xf bound_ctrl:0
  v_add_f32_dpp v217, v201, v200 row_shl:4 row_mask:0xf bank_mask:0xf bound_ctrl:0
  v_add_f32_dpp v218, v205, v204 row_shl:4 row_mask:0xf bank_mask:0xf bound_ctrl:0
  v_add_f32_dpp v219, v209, v208 row_shl:4 row_mask:0xf bank_mask:0xf bound_ctrl:0
  v_add_f32_dpp v212, v18, v212 row_shl:8 row_mask:0xf bank_mask:0xf bound_ctrl:0
  v_add_f32_dpp v213, v22, v213 row_shl:8 row_mask:0xf bank_mask:0xf bound_ctrl:0
  v_add_f32_dpp v214, v26, v214 row_shl:8 row_mask:0xf bank_mask:0xf bound_ctrl:0
  v_add_f32_dpp v215, v30, v215 row_shl:8 row_mask:0xf bank_mask:0xf bound_ctrl:0
  v_add_f32_dpp v216, v198, v216 row_shl:8 row_mask:0xf bank_mask:0xf bound_ctrl:0
  v_add_f32_dpp v217, v202, v217 row_shl:8 row_mask:0xf bank_mask:0xf bound_ctrl:0
  v_add_f32_dpp v218, v206, v218 row_shl:8 row_mask:0xf bank_mask:0xf bound_ctrl:0
  v_add_f32_dpp v219, v210, v219 row_shl:8 row_mask:0xf bank_mask:0xf bound_ctrl:0
  v_add_f32_dpp v212, v19, v212 row_shl:12 row_mask:0xf bank_mask:0xf bound_ctrl:0
  v_add_f32_dpp v213, v23, v213 row_shl:12 row_mask:0xf bank_mask:0xf bound_ctrl:0
  v_add_f32_dpp v214, v27, v214 row_shl:12 row_mask:0xf bank_mask:0xf bound_ctrl:0
  v_add_f32_dpp v215, v31, v215 row_shl:12 row_mask:0xf bank_mask:0xf bound_ctrl:0
  v_add_f32_dpp v216, v199, v216 row_shl:12 row_mask:0xf bank_mask:0xf bound_ctrl:0
  v_add_f32_dpp v217, v203, v217 row_shl:12 row_mask:0xf bank_mask:0xf bound_ctrl:0
  v_add_f32_dpp v218, v207, v218 row_shl:12 row_mask:0xf bank_mask:0xf bound_ctrl:0
  v_add_f32_dpp v219, v211, v219 row_shl:12 row_mask:0xf bank_mask:0xf bound_ctrl:0
  v_cvt_pk_bf16_f32 v16, v212, v213
  v_cvt_pk_bf16_f32 v17, v214, v215
  v_cvt_pk_bf16_f32 v18, v216, v217
  v_cvt_pk_bf16_f32 v19, v218, v219
  v_lshlrev_b32 v212, 16, v16
  v_and_b32 v213, 0xffff0000, v16
  v_lshlrev_b32 v214, 16, v17
  v_and_b32 v215, 0xffff0000, v17
  v_lshlrev_b32 v216, 16, v18
  v_and_b32 v217, 0xffff0000, v18
  v_lshlrev_b32 v218, 16, v19
  v_and_b32 v219, 0xffff0000, v19
  v_mul_f32 v212, s72, v212
  v_mul_f32 v213, s72, v213
  v_mul_f32 v214, s72, v214
  v_mul_f32 v215, s72, v215
  v_mul_f32 v216, s72, v216
  v_mul_f32 v217, s72, v217
  v_mul_f32 v218, s72, v218
  v_mul_f32 v219, s72, v219
  v_cvt_pk_bf16_f32 v52, v212, v213
  v_cvt_pk_bf16_f32 v53, v214, v215
  v_cvt_pk_bf16_f32 v54, v216, v217
  v_cvt_pk_bf16_f32 v55, v218, v219
  v_max3_f32 v12, v212, v213, v12
  v_max3_f32 v12, v214, v215, v12
  v_max3_f32 v12, v216, v217, v12
  v_max3_f32 v12, v218, v219, v12
  s_waitcnt vmcnt(24)
  v_mfma_f32_16x16x32_bf16 v[16:19], v[128:131], v[192:195], 0
  v_mfma_f32_16x16x32_bf16 v[20:23], v[132:135], v[192:195], 0
  v_mfma_f32_16x16x32_bf16 v[24:27], v[136:139], v[192:195], 0
  v_mfma_f32_16x16x32_bf16 v[28:31], v[140:143], v[192:195], 0
  v_mfma_f32_16x16x32_bf16 v[196:199], v[144:147], v[192:195], 0
  v_mfma_f32_16x16x32_bf16 v[200:203], v[148:151], v[192:195], 0
  v_mfma_f32_16x16x32_bf16 v[204:207], v[152:155], v[192:195], 0
  v_mfma_f32_16x16x32_bf16 v[208:211], v[156:159], v[192:195], 0
  buffer_load_dwordx4 v[128:131], v6, s[32:35], s76 offen offset:0 nt
  buffer_load_dwordx4 v[132:135], v6, s[32:35], s76 offen offset:1024 nt
  buffer_load_dwordx4 v[136:139], v6, s[32:35], s76 offen offset:2048 nt
  buffer_load_dwordx4 v[140:143], v6, s[32:35], s76 offen offset:3072 nt
  buffer_load_dwordx4 v[144:147], v6, s[32:35], s77 offen offset:0 nt
  buffer_load_dwordx4 v[148:151], v6, s[32:35], s77 offen offset:1024 nt
  buffer_load_dwordx4 v[152:155], v6, s[32:35], s77 offen offset:2048 nt
  buffer_load_dwordx4 v[156:159], v6, s[32:35], s77 offen offset:3072 nt
  s_add_u32 s99, s76, 8192
  s_and_b32 s99, s99, 0xffff
  s_and_b32 s76, s76, 0xffff0000
  s_or_b32 s76, s76, s99
  s_add_u32 s77, s76, 4096
  v_add_f32_dpp v212, v17, v16 row_shl:4 row_mask:0xf bank_mask:0xf bound_ctrl:0
  v_add_f32_dpp v213, v21, v20 row_shl:4 row_mask:0xf bank_mask:0xf bound_ctrl:0
  v_add_f32_dpp v214, v25, v24 row_shl:4 row_mask:0xf bank_mask:0xf bound_ctrl:0
  v_add_f32_dpp v215, v29, v28 row_shl:4 row_mask:0xf bank_mask:0xf bound_ctrl:0
  v_add_f32_dpp v216, v197, v196 row_shl:4 row_mask:0xf bank_mask:0xf bound_ctrl:0
  v_add_f32_dpp v217, v201, v200 row_shl:4 row_mask:0xf bank_mask:0xf bound_ctrl:0
  v_add_f32_dpp v218, v205, v204 row_shl:4 row_mask:0xf bank_mask:0xf bound_ctrl:0
  v_add_f32_dpp v219, v209, v208 row_shl:4 row_mask:0xf bank_mask:0xf bound_ctrl:0
  v_add_f32_dpp v212, v18, v212 row_shl:8 row_mask:0xf bank_mask:0xf bound_ctrl:0
  v_add_f32_dpp v213, v22, v213 row_shl:8 row_mask:0xf bank_mask:0xf bound_ctrl:0
  v_add_f32_dpp v214, v26, v214 row_shl:8 row_mask:0xf bank_mask:0xf bound_ctrl:0
  v_add_f32_dpp v215, v30, v215 row_shl:8 row_mask:0xf bank_mask:0xf bound_ctrl:0
  v_add_f32_dpp v216, v198, v216 row_shl:8 row_mask:0xf bank_mask:0xf bound_ctrl:0
  v_add_f32_dpp v217, v202, v217 row_shl:8 row_mask:0xf bank_mask:0xf bound_ctrl:0
  v_add_f32_dpp v218, v206, v218 row_shl:8 row_mask:0xf bank_mask:0xf bound_ctrl:0
  v_add_f32_dpp v219, v210, v219 row_shl:8 row_mask:0xf bank_mask:0xf bound_ctrl:0
  v_add_f32_dpp v212, v19, v212 row_shl:12 row_mask:0xf bank_mask:0xf bound_ctrl:0
  v_add_f32_dpp v213, v23, v213 row_shl:12 row_mask:0xf bank_mask:0xf bound_ctrl:0
  v_add_f32_dpp v214, v27, v214 row_shl:12 row_mask:0xf bank_mask:0xf bound_ctrl:0
  v_add_f32_dpp v215, v31, v215 row_shl:12 row_mask:0xf bank_mask:0xf bound_ctrl:0
  v_add_f32_dpp v216, v199, v216 row_shl:12 row_mask:0xf bank_mask:0xf bound_ctrl:0
  v_add_f32_dpp v217, v203, v217 row_shl:12 row_mask:0xf bank_mask:0xf bound_ctrl:0
  v_add_f32_dpp v218, v207, v218 row_shl:12 row_mask:0xf bank_mask:0xf bound_ctrl:0
  v_add_f32_dpp v219, v211, v219 row_shl:12 row_mask:0xf bank_mask:0xf bound_ctrl:0
  v_cvt_pk_bf16_f32 v16, v212, v213
  v_cvt_pk_bf16_f32 v17, v214, v215
  v_cvt_pk_bf16_f32 v18, v216, v217
  v_cvt_pk_bf16_f32 v19, v218, v219
  v_lshlrev_b32 v212, 16, v16
  v_and_b32 v213, 0xffff0000, v16
  v_lshlrev_b32 v214, 16, v17
  v_and_b32 v215, 0xffff0000, v17
  v_lshlrev_b32 v216, 16, v18
  v_and_b32 v217, 0xffff0000, v18
  v_lshlrev_b32 v218, 16, v19
  v_and_b32 v219, 0xffff0000, v19
  v_mul_f32 v212, s72, v212
  v_mul_f32 v213, s72, v213
  v_mul_f32 v214, s72, v214
  v_mul_f32 v215, s72, v215
  v_mul_f32 v216, s72, v216
  v_mul_f32 v217, s72, v217
  v_mul_f32 v218, s72, v218
  v_mul_f32 v219, s72, v219
  v_cvt_pk_bf16_f32 v56, v212, v213
  v_cvt_pk_bf16_f32 v57, v214, v215
  v_cvt_pk_bf16_f32 v58, v216, v217
  v_cvt_pk_bf16_f32 v59, v218, v219
  v_max3_f32 v12, v212, v213, v12
  v_max3_f32 v12, v214, v215, v12
  v_max3_f32 v12, v216, v217, v12
  v_max3_f32 v12, v218, v219, v12
  s_waitcnt vmcnt(24)
  v_mfma_f32_16x16x32_bf16 v[16:19], v[160:163], v[192:195], 0
  v_mfma_f32_16x16x32_bf16 v[20:23], v[164:167], v[192:195], 0
  v_mfma_f32_16x16x32_bf16 v[24:27], v[168:171], v[192:195], 0
  v_mfma_f32_16x16x32_bf16 v[28:31], v[172:175], v[192:195], 0
  v_mfma_f32_16x16x32_bf16 v[196:199], v[176:179], v[192:195], 0
  v_mfma_f32_16x16x32_bf16 v[200:203], v[180:183], v[192:195], 0
  v_mfma_f32_16x16x32_bf16 v[204:207], v[184:187], v[192:195], 0
  v_mfma_f32_16x16x32_bf16 v[208:211], v[188:191], v[192:195], 0
  buffer_load_dwordx4 v[160:163], v6, s[32:35], s76 offen offset:0 nt
  buffer_load_dwordx4 v[164:167], v6, s[32:35], s76 offen offset:1024 nt
  buffer_load_dwordx4 v[168:171], v6, s[32:35], s76 offen offset:2048 nt
  buffer_load_dwordx4 v[172:175], v6, s[32:35], s76 offen offset:3072 nt
  buffer_load_dwordx4 v[176:179], v6, s[32:35], s77 offen offset:0 nt
  buffer_load_dwordx4 v[180:183], v6, s[32:35], s77 offen offset:1024 nt
  buffer_load_dwordx4 v[184:187], v6, s[32:35], s77 offen offset:2048 nt
  buffer_load_dwordx4 v[188:191], v6, s[32:35], s77 offen offset:3072 nt
  s_add_u32 s99, s76, 8192
  s_and_b32 s99, s99, 0xffff
  s_and_b32 s76, s76, 0xffff0000
  s_or_b32 s76, s76, s99
  s_add_u32 s77, s76, 4096
  v_add_f32_dpp v212, v17, v16 row_shl:4 row_mask:0xf bank_mask:0xf bound_ctrl:0
  v_add_f32_dpp v213, v21, v20 row_shl:4 row_mask:0xf bank_mask:0xf bound_ctrl:0
  v_add_f32_dpp v214, v25, v24 row_shl:4 row_mask:0xf bank_mask:0xf bound_ctrl:0
  v_add_f32_dpp v215, v29, v28 row_shl:4 row_mask:0xf bank_mask:0xf bound_ctrl:0
  v_add_f32_dpp v216, v197, v196 row_shl:4 row_mask:0xf bank_mask:0xf bound_ctrl:0
  v_add_f32_dpp v217, v201, v200 row_shl:4 row_mask:0xf bank_mask:0xf bound_ctrl:0
  v_add_f32_dpp v218, v205, v204 row_shl:4 row_mask:0xf bank_mask:0xf bound_ctrl:0
  v_add_f32_dpp v219, v209, v208 row_shl:4 row_mask:0xf bank_mask:0xf bound_ctrl:0
  v_add_f32_dpp v212, v18, v212 row_shl:8 row_mask:0xf bank_mask:0xf bound_ctrl:0
  v_add_f32_dpp v213, v22, v213 row_shl:8 row_mask:0xf bank_mask:0xf bound_ctrl:0
  v_add_f32_dpp v214, v26, v214 row_shl:8 row_mask:0xf bank_mask:0xf bound_ctrl:0
  v_add_f32_dpp v215, v30, v215 row_shl:8 row_mask:0xf bank_mask:0xf bound_ctrl:0
  v_add_f32_dpp v216, v198, v216 row_shl:8 row_mask:0xf bank_mask:0xf bound_ctrl:0
  v_add_f32_dpp v217, v202, v217 row_shl:8 row_mask:0xf bank_mask:0xf bound_ctrl:0
  v_add_f32_dpp v218, v206, v218 row_shl:8 row_mask:0xf bank_mask:0xf bound_ctrl:0
  v_add_f32_dpp v219, v210, v219 row_shl:8 row_mask:0xf bank_mask:0xf bound_ctrl:0
  v_add_f32_dpp v212, v19, v212 row_shl:12 row_mask:0xf bank_mask:0xf bound_ctrl:0
  v_add_f32_dpp v213, v23, v213 row_shl:12 row_mask:0xf bank_mask:0xf bound_ctrl:0
  v_add_f32_dpp v214, v27, v214 row_shl:12 row_mask:0xf bank_mask:0xf bound_ctrl:0
  v_add_f32_dpp v215, v31, v215 row_shl:12 row_mask:0xf bank_mask:0xf bound_ctrl:0
  v_add_f32_dpp v216, v199, v216 row_shl:12 row_mask:0xf bank_mask:0xf bound_ctrl:0
  v_add_f32_dpp v217, v203, v217 row_shl:12 row_mask:0xf bank_mask:0xf bound_ctrl:0
  v_add_f32_dpp v218, v207, v218 row_shl:12 row_mask:0xf bank_mask:0xf bound_ctrl:0
  v_add_f32_dpp v219, v211, v219 row_shl:12 row_mask:0xf bank_mask:0xf bound_ctrl:0
  v_cvt_pk_bf16_f32 v16, v212, v213
  v_cvt_pk_bf16_f32 v17, v214, v215
  v_cvt_pk_bf16_f32 v18, v216, v217
  v_cvt_pk_bf16_f32 v19, v218, v219
  v_lshlrev_b32 v212, 16, v16
  v_and_b32 v213, 0xffff0000, v16
  v_lshlrev_b32 v214, 16, v17
  v_and_b32 v215, 0xffff0000, v17
  v_lshlrev_b32 v216, 16, v18
  v_and_b32 v217, 0xffff0000, v18
  v_lshlrev_b32 v218, 16, v19
  v_and_b32 v219, 0xffff0000, v19
  v_mul_f32 v212, s72, v212
  v_mul_f32 v213, s72, v213
  v_mul_f32 v214, s72, v214
  v_mul_f32 v215, s72, v215
  v_mul_f32 v216, s72, v216
  v_mul_f32 v217, s72, v217
  v_mul_f32 v218, s72, v218
  v_mul_f32 v219, s72, v219
  v_cvt_pk_bf16_f32 v60, v212, v213
  v_cvt_pk_bf16_f32 v61, v214, v215
  v_cvt_pk_bf16_f32 v62, v216, v217
  v_cvt_pk_bf16_f32 v63, v218, v219
  v_max3_f32 v12, v212, v213, v12
  v_max3_f32 v12, v214, v215, v12
  v_max3_f32 v12, v216, v217, v12
  v_max3_f32 v12, v218, v219, v12
  v_lshlrev_b32 v8, 2, v1
  v_xor_b32 v9, 64, v8
  ds_bpermute_b32 v13, v9, v12
  s_waitcnt lgkmcnt(0)
  v_max_f32 v12, v12, v13
  v_xor_b32 v9, 128, v8
  ds_bpermute_b32 v13, v9, v12
  s_waitcnt lgkmcnt(0)
  v_max_f32 v12, v12, v13
  v_cvt_pk_bf16_f32 v13, v12, v12
  v_lshlrev_b32 v12, 16, v13
  v_mul_f32 v13, s73, v12
  v_mov_b32 v14, 0
  v_mov_b32 v15, 0
  v_lshlrev_b32 v16, 16, v32
  v_and_b32 v17, 0xffff0000, v32
  v_lshlrev_b32 v18, 16, v33
  v_and_b32 v19, 0xffff0000, v33
  v_lshlrev_b32 v20, 16, v34
  v_and_b32 v21, 0xffff0000, v34
  v_lshlrev_b32 v22, 16, v35
  v_and_b32 v23, 0xffff0000, v35
  v_fma_f32 v16, v16, s73, -v13
  v_fma_f32 v17, v17, s73, -v13
  v_fma_f32 v18, v18, s73, -v13
  v_fma_f32 v19, v19, s73, -v13
  v_fma_f32 v20, v20, s73, -v13
  v_fma_f32 v21, v21, s73, -v13
  v_fma_f32 v22, v22, s73, -v13
  v_fma_f32 v23, v23, s73, -v13
  v_exp_f32 v16, v16
  v_exp_f32 v17, v17
  v_exp_f32 v18, v18
  v_exp_f32 v19, v19
  v_exp_f32 v20, v20
  v_exp_f32 v21, v21
  v_exp_f32 v22, v22
  v_exp_f32 v23, v23
  s_nop 0
  v_cvt_pk_bf16_f32 v24, v16, v17
  v_cvt_pk_bf16_f32 v25, v18, v19
  v_cvt_pk_bf16_f32 v26, v20, v21
  v_cvt_pk_bf16_f32 v27, v22, v23
  v_add_f32 v14, v14, v16
  v_add_f32 v15, v15, v17
  v_add_f32 v14, v14, v18
  v_add_f32 v15, v15, v19
  v_add_f32 v14, v14, v20
  v_add_f32 v15, v15, v21
  v_add_f32 v14, v14, v22
  v_add_f32 v15, v15, v23
  s_waitcnt vmcnt(24)
  v_perm_b32 v192, v68, v64, s70
  v_perm_b32 v193, v76, v72, s70
  v_perm_b32 v194, v84, v80, s70
  v_perm_b32 v195, v92, v88, s70
  v_perm_b32 v196, v68, v64, s71
  v_perm_b32 v197, v76, v72, s71
  v_perm_b32 v198, v84, v80, s71
  v_perm_b32 v199, v92, v88, s71
  v_perm_b32 v200, v69, v65, s70
  v_perm_b32 v201, v77, v73, s70
  v_perm_b32 v202, v85, v81, s70
  v_perm_b32 v203, v93, v89, s70
  v_perm_b32 v204, v69, v65, s71
  v_perm_b32 v205, v77, v73, s71
  v_perm_b32 v206, v85, v81, s71
  v_perm_b32 v207, v93, v89, s71
  v_perm_b32 v208, v70, v66, s70
  v_perm_b32 v209, v78, v74, s70
  v_perm_b32 v210, v86, v82, s70
  v_perm_b32 v211, v94, v90, s70
  v_perm_b32 v212, v70, v66, s71
  v_perm_b32 v213, v78, v74, s71
  v_perm_b32 v214, v86, v82, s71
  v_perm_b32 v215, v94, v90, s71
  v_perm_b32 v216, v71, v67, s70
  v_perm_b32 v217, v79, v75, s70
  v_perm_b32 v218, v87, v83, s70
  v_perm_b32 v219, v95, v91, s70
  v_perm_b32 v220, v71, v67, s71
  v_perm_b32 v221, v79, v75, s71
  v_perm_b32 v222, v87, v83, s71
  v_perm_b32 v223, v95, v91, s71
  s_nop 1
  v_mfma_f32_16x16x32_bf16 v[224:227], v[192:195], v[24:27], 0
  v_mfma_f32_16x16x32_bf16 v[228:231], v[196:199], v[24:27], 0
  v_mfma_f32_16x16x32_bf16 v[232:235], v[200:203], v[24:27], 0
  v_mfma_f32_16x16x32_bf16 v[236:239], v[204:207], v[24:27], 0
  v_mfma_f32_16x16x32_bf16 v[240:243], v[208:211], v[24:27], 0
  v_mfma_f32_16x16x32_bf16 v[244:247], v[212:215], v[24:27], 0
  v_mfma_f32_16x16x32_bf16 v[248:251], v[216:219], v[24:27], 0
  v_mfma_f32_16x16x32_bf16 v[252:255], v[220:223], v[24:27], 0
  buffer_load_dwordx4 v[64:67], v6, s[32:35], s76 offen offset:0 nt
  buffer_load_dwordx4 v[68:71], v6, s[32:35], s76 offen offset:1024 nt
  buffer_load_dwordx4 v[72:75], v6, s[32:35], s76 offen offset:2048 nt
  buffer_load_dwordx4 v[76:79], v6, s[32:35], s76 offen offset:3072 nt
  buffer_load_dwordx4 v[80:83], v6, s[32:35], s77 offen offset:0 nt
  buffer_load_dwordx4 v[84:87], v6, s[32:35], s77 offen offset:1024 nt
  buffer_load_dwordx4 v[88:91], v6, s[32:35], s77 offen offset:2048 nt
  buffer_load_dwordx4 v[92:95], v6, s[32:35], s77 offen offset:3072 nt
  s_add_u32 s99, s76, 8192
  s_and_b32 s99, s99, 0xffff
  s_and_b32 s76, s76, 0xffff0000
  s_or_b32 s76, s76, s99
  s_add_u32 s77, s76, 4096
  v_lshlrev_b32 v16, 16, v36
  v_and_b32 v17, 0xffff0000, v36
  v_lshlrev_b32 v18, 16, v37
  v_and_b32 v19, 0xffff0000, v37
  v_lshlrev_b32 v20, 16, v38
  v_and_b32 v21, 0xffff0000, v38
  v_lshlrev_b32 v22, 16, v39
  v_and_b32 v23, 0xffff0000, v39
  v_fma_f32 v16, v16, s73, -v13
  v_fma_f32 v17, v17, s73, -v13
  v_fma_f32 v18, v18, s73, -v13
  v_fma_f32 v19, v19, s73, -v13
  v_fma_f32 v20, v20, s73, -v13
  v_fma_f32 v21, v21, s73, -v13
  v_fma_f32 v22, v22, s73, -v13
  v_fma_f32 v23, v23, s73, -v13
  v_exp_f32 v16, v16
  v_exp_f32 v17, v17
  v_exp_f32 v18, v18
  v_exp_f32 v19, v19
  v_exp_f32 v20, v20
  v_exp_f32 v21, v21
  v_exp_f32 v22, v22
  v_exp_f32 v23, v23
  s_nop 0
  v_cvt_pk_bf16_f32 v24, v16, v17
  v_cvt_pk_bf16_f32 v25, v18, v19
  v_cvt_pk_bf16_f32 v26, v20, v21
  v_cvt_pk_bf16_f32 v27, v22, v23
  v_add_f32 v14, v14, v16
  v_add_f32 v15, v15, v17
  v_add_f32 v14, v14, v18
  v_add_f32 v15, v15, v19
  v_add_f32 v14, v14, v20
  v_add_f32 v15, v15, v21
  v_add_f32 v14, v14, v22
  v_add_f32 v15, v15, v23
  s_waitcnt vmcnt(24)
  v_perm_b32 v192, v100, v96, s70
  v_perm_b32 v193, v108, v104, s70
  v_perm_b32 v194, v116, v112, s70
  v_perm_b32 v195, v124, v120, s70
  v_perm_b32 v196, v100, v96, s71
  v_perm_b32 v197, v108, v104, s71
  v_perm_b32 v198, v116, v112, s71
  v_perm_b32 v199, v124, v120, s71
  v_perm_b32 v200, v101, v97, s70
  v_perm_b32 v201, v109, v105, s70
  v_perm_b32 v202, v117, v113, s70
  v_perm_b32 v203, v125, v121, s70
  v_perm_b32 v204, v101, v97, s71
  v_perm_b32 v205, v109, v105, s71
  v_perm_b32 v206, v117, v113, s71
  v_perm_b32 v207, v125, v121, s71
  v_perm_b32 v208, v102, v98, s70
  v_perm_b32 v209, v110, v106, s70
  v_perm_b32 v210, v118, v114, s70
  v_perm_b32 v211, v126, v122, s70
  v_perm_b32 v212, v102, v98, s71
  v_perm_b32 v213, v110, v106, s71
  v_perm_b32 v214, v118, v114, s71
  v_perm_b32 v215, v126, v122, s71
  v_perm_b32 v216, v103, v99, s70
  v_perm_b32 v217, v111, v107, s70
  v_perm_b32 v218, v119, v115, s70
  v_perm_b32 v219, v127, v123, s70
  v_perm_b32 v220, v103, v99, s71
  v_perm_b32 v221, v111, v107, s71
  v_perm_b32 v222, v119, v115, s71
  v_perm_b32 v223, v127, v123, s71
  s_nop 1
  v_mfma_f32_16x16x32_bf16 v[224:227], v[192:195], v[24:27], v[224:227]
  v_mfma_f32_16x16x32_bf16 v[228:231], v[196:199], v[24:27], v[228:231]
  v_mfma_f32_16x16x32_bf16 v[232:235], v[200:203], v[24:27], v[232:235]
  v_mfma_f32_16x16x32_bf16 v[236:239], v[204:207], v[24:27], v[236:239]
  v_mfma_f32_16x16x32_bf16 v[240:243], v[208:211], v[24:27], v[240:243]
  v_mfma_f32_16x16x32_bf16 v[244:247], v[212:215], v[24:27], v[244:247]
  v_mfma_f32_16x16x32_bf16 v[248:251], v[216:219], v[24:27], v[248:251]
  v_mfma_f32_16x16x32_bf16 v[252:255], v[220:223], v[24:27], v[252:255]
  buffer_load_dwordx4 v[96:99], v6, s[32:35], s76 offen offset:0 nt
  buffer_load_dwordx4 v[100:103], v6, s[32:35], s76 offen offset:1024 nt
  buffer_load_dwordx4 v[104:107], v6, s[32:35], s76 offen offset:2048 nt
  buffer_load_dwordx4 v[108:111], v6, s[32:35], s76 offen offset:3072 nt
  buffer_load_dwordx4 v[112:115], v6, s[32:35], s77 offen offset:0 nt
  buffer_load_dwordx4 v[116:119], v6, s[32:35], s77 offen offset:1024 nt
  buffer_load_dwordx4 v[120:123], v6, s[32:35], s77 offen offset:2048 nt
  buffer_load_dwordx4 v[124:127], v6, s[32:35], s77 offen offset:3072 nt
  s_add_u32 s99, s76, 8192
  s_and_b32 s99, s99, 0xffff
  s_and_b32 s76, s76, 0xffff0000
  s_or_b32 s76, s76, s99
  s_add_u32 s77, s76, 4096
  v_lshlrev_b32 v16, 16, v40
  v_and_b32 v17, 0xffff0000, v40
  v_lshlrev_b32 v18, 16, v41
  v_and_b32 v19, 0xffff0000, v41
  v_lshlrev_b32 v20, 16, v42
  v_and_b32 v21, 0xffff0000, v42
  v_lshlrev_b32 v22, 16, v43
  v_and_b32 v23, 0xffff0000, v43
  v_fma_f32 v16, v16, s73, -v13
  v_fma_f32 v17, v17, s73, -v13
  v_fma_f32 v18, v18, s73, -v13
  v_fma_f32 v19, v19, s73, -v13
  v_fma_f32 v20, v20, s73, -v13
  v_fma_f32 v21, v21, s73, -v13
  v_fma_f32 v22, v22, s73, -v13
  v_fma_f32 v23, v23, s73, -v13
  v_exp_f32 v16, v16
  v_exp_f32 v17, v17
  v_exp_f32 v18, v18
  v_exp_f32 v19, v19
  v_exp_f32 v20, v20
  v_exp_f32 v21, v21
  v_exp_f32 v22, v22
  v_exp_f32 v23, v23
  s_nop 0
  v_cvt_pk_bf16_f32 v24, v16, v17
  v_cvt_pk_bf16_f32 v25, v18, v19
  v_cvt_pk_bf16_f32 v26, v20, v21
  v_cvt_pk_bf16_f32 v27, v22, v23
  v_add_f32 v14, v14, v16
  v_add_f32 v15, v15, v17
  v_add_f32 v14, v14, v18
  v_add_f32 v15, v15, v19
  v_add_f32 v14, v14, v20
  v_add_f32 v15, v15, v21
  v_add_f32 v14, v14, v22
  v_add_f32 v15, v15, v23
  s_waitcnt vmcnt(24)
  v_perm_b32 v192, v132, v128, s70
  v_perm_b32 v193, v140, v136, s70
  v_perm_b32 v194, v148, v144, s70
  v_perm_b32 v195, v156, v152, s70
  v_perm_b32 v196, v132, v128, s71
  v_perm_b32 v197, v140, v136, s71
  v_perm_b32 v198, v148, v144, s71
  v_perm_b32 v199, v156, v152, s71
  v_perm_b32 v200, v133, v129, s70
  v_perm_b32 v201, v141, v137, s70
  v_perm_b32 v202, v149, v145, s70
  v_perm_b32 v203, v157, v153, s70
  v_perm_b32 v204, v133, v129, s71
  v_perm_b32 v205, v141, v137, s71
  v_perm_b32 v206, v149, v145, s71
  v_perm_b32 v207, v157, v153, s71
  v_perm_b32 v208, v134, v130, s70
  v_perm_b32 v209, v142, v138, s70
  v_perm_b32 v210, v150, v146, s70
  v_perm_b32 v211, v158, v154, s70
  v_perm_b32 v212, v134, v130, s71
  v_perm_b32 v213, v142, v138, s71
  v_perm_b32 v214, v150, v146, s71
  v_perm_b32 v215, v158, v154, s71
  v_perm_b32 v216, v135, v131, s70
  v_perm_b32 v217, v143, v139, s70
  v_perm_b32 v218, v151, v147, s70
  v_perm_b32 v219, v159, v155, s70
  v_perm_b32 v220, v135, v131, s71
  v_perm_b32 v221, v143, v139, s71
  v_perm_b32 v222, v151, v147, s71
  v_perm_b32 v223, v159, v155, s71
  s_nop 1
  v_mfma_f32_16x16x32_bf16 v[224:227], v[192:195], v[24:27], v[224:227]
  v_mfma_f32_16x16x32_bf16 v[228:231], v[196:199], v[24:27], v[228:231]
  v_mfma_f32_16x16x32_bf16 v[232:235], v[200:203], v[24:27], v[232:235]
  v_mfma_f32_16x16x32_bf16 v[236:239], v[204:207], v[24:27], v[236:239]
  v_mfma_f32_16x16x32_bf16 v[240:243], v[208:211], v[24:27], v[240:243]
  v_mfma_f32_16x16x32_bf16 v[244:247], v[212:215], v[24:27], v[244:247]
  v_mfma_f32_16x16x32_bf16 v[248:251], v[216:219], v[24:27], v[248:251]
  v_mfma_f32_16x16x32_bf16 v[252:255], v[220:223], v[24:27], v[252:255]
  buffer_load_dwordx4 v[128:131], v6, s[32:35], s76 offen offset:0 nt
  buffer_load_dwordx4 v[132:135], v6, s[32:35], s76 offen offset:1024 nt
  buffer_load_dwordx4 v[136:139], v6, s[32:35], s76 offen offset:2048 nt
  buffer_load_dwordx4 v[140:143], v6, s[32:35], s76 offen offset:3072 nt
  buffer_load_dwordx4 v[144:147], v6, s[32:35], s77 offen offset:0 nt
  buffer_load_dwordx4 v[148:151], v6, s[32:35], s77 offen offset:1024 nt
  buffer_load_dwordx4 v[152:155], v6, s[32:35], s77 offen offset:2048 nt
  buffer_load_dwordx4 v[156:159], v6, s[32:35], s77 offen offset:3072 nt
  s_add_u32 s99, s76, 8192
  s_and_b32 s99, s99, 0xffff
  s_and_b32 s76, s76, 0xffff0000
  s_or_b32 s76, s76, s99
  s_add_u32 s77, s76, 4096
  v_lshlrev_b32 v16, 16, v44
  v_and_b32 v17, 0xffff0000, v44
  v_lshlrev_b32 v18, 16, v45
  v_and_b32 v19, 0xffff0000, v45
  v_lshlrev_b32 v20, 16, v46
  v_and_b32 v21, 0xffff0000, v46
  v_lshlrev_b32 v22, 16, v47
  v_and_b32 v23, 0xffff0000, v47
  v_fma_f32 v16, v16, s73, -v13
  v_fma_f32 v17, v17, s73, -v13
  v_fma_f32 v18, v18, s73, -v13
  v_fma_f32 v19, v19, s73, -v13
  v_fma_f32 v20, v20, s73, -v13
  v_fma_f32 v21, v21, s73, -v13
  v_fma_f32 v22, v22, s73, -v13
  v_fma_f32 v23, v23, s73, -v13
  v_exp_f32 v16, v16
  v_exp_f32 v17, v17
  v_exp_f32 v18, v18
  v_exp_f32 v19, v19
  v_exp_f32 v20, v20
  v_exp_f32 v21, v21
  v_exp_f32 v22, v22
  v_exp_f32 v23, v23
  s_nop 0
  v_cvt_pk_bf16_f32 v24, v16, v17
  v_cvt_pk_bf16_f32 v25, v18, v19
  v_cvt_pk_bf16_f32 v26, v20, v21
  v_cvt_pk_bf16_f32 v27, v22, v23
  v_add_f32 v14, v14, v16
  v_add_f32 v15, v15, v17
  v_add_f32 v14, v14, v18
  v_add_f32 v15, v15, v19
  v_add_f32 v14, v14, v20
  v_add_f32 v15, v15, v21
  v_add_f32 v14, v14, v22
  v_add_f32 v15, v15, v23
  s_waitcnt vmcnt(24)
  v_perm_b32 v192, v164, v160, s70
  v_perm_b32 v193, v172, v168, s70
  v_perm_b32 v194, v180, v176, s70
  v_perm_b32 v195, v188, v184, s70
  v_perm_b32 v196, v164, v160, s71
  v_perm_b32 v197, v172, v168, s71
  v_perm_b32 v198, v180, v176, s71
  v_perm_b32 v199, v188, v184, s71
  v_perm_b32 v200, v165, v161, s70
  v_perm_b32 v201, v173, v169, s70
  v_perm_b32 v202, v181, v177, s70
  v_perm_b32 v203, v189, v185, s70
  v_perm_b32 v204, v165, v161, s71
  v_perm_b32 v205, v173, v169, s71
  v_perm_b32 v206, v181, v177, s71
  v_perm_b32 v207, v189, v185, s71
  v_perm_b32 v208, v166, v162, s70
  v_perm_b32 v209, v174, v170, s70
  v_perm_b32 v210, v182, v178, s70
  v_perm_b32 v211, v190, v186, s70
  v_perm_b32 v212, v166, v162, s71
  v_perm_b32 v213, v174, v170, s71
  v_perm_b32 v214, v182, v178, s71
  v_perm_b32 v215, v190, v186, s71
  v_perm_b32 v216, v167, v163, s70
  v_perm_b32 v217, v175, v171, s70
  v_perm_b32 v218, v183, v179, s70
  v_perm_b32 v219, v191, v187, s70
  v_perm_b32 v220, v167, v163, s71
  v_perm_b32 v221, v175, v171, s71
  v_perm_b32 v222, v183, v179, s71
  v_perm_b32 v223, v191, v187, s71
  s_nop 1
  v_mfma_f32_16x16x32_bf16 v[224:227], v[192:195], v[24:27], v[224:227]
  v_mfma_f32_16x16x32_bf16 v[228:231], v[196:199], v[24:27], v[228:231]
  v_mfma_f32_16x16x32_bf16 v[232:235], v[200:203], v[24:27], v[232:235]
  v_mfma_f32_16x16x32_bf16 v[236:239], v[204:207], v[24:27], v[236:239]
  v_mfma_f32_16x16x32_bf16 v[240:243], v[208:211], v[24:27], v[240:243]
  v_mfma_f32_16x16x32_bf16 v[244:247], v[212:215], v[24:27], v[244:247]
  v_mfma_f32_16x16x32_bf16 v[248:251], v[216:219], v[24:27], v[248:251]
  v_mfma_f32_16x16x32_bf16 v[252:255], v[220:223], v[24:27], v[252:255]
  buffer_load_dwordx4 v[160:163], v6, s[32:35], s76 offen offset:0 nt
  buffer_load_dwordx4 v[164:167], v6, s[32:35], s76 offen offset:1024 nt
  buffer_load_dwordx4 v[168:171], v6, s[32:35], s76 offen offset:2048 nt
  buffer_load_dwordx4 v[172:175], v6, s[32:35], s76 offen offset:3072 nt
  buffer_load_dwordx4 v[176:179], v6, s[32:35], s77 offen offset:0 nt
  buffer_load_dwordx4 v[180:183], v6, s[32:35], s77 offen offset:1024 nt
  buffer_load_dwordx4 v[184:187], v6, s[32:35], s77 offen offset:2048 nt
  buffer_load_dwordx4 v[188:191], v6, s[32:35], s77 offen offset:3072 nt
  s_add_u32 s99, s76, 8192
  s_and_b32 s99, s99, 0xffff
  s_and_b32 s76, s76, 0xffff0000
  s_or_b32 s76, s76, s99
  s_add_u32 s77, s76, 4096
  v_lshlrev_b32 v16, 16, v48
  v_and_b32 v17, 0xffff0000, v48
  v_lshlrev_b32 v18, 16, v49
  v_and_b32 v19, 0xffff0000, v49
  v_lshlrev_b32 v20, 16, v50
  v_and_b32 v21, 0xffff0000, v50
  v_lshlrev_b32 v22, 16, v51
  v_and_b32 v23, 0xffff0000, v51
  v_fma_f32 v16, v16, s73, -v13
  v_fma_f32 v17, v17, s73, -v13
  v_fma_f32 v18, v18, s73, -v13
  v_fma_f32 v19, v19, s73, -v13
  v_fma_f32 v20, v20, s73, -v13
  v_fma_f32 v21, v21, s73, -v13
  v_fma_f32 v22, v22, s73, -v13
  v_fma_f32 v23, v23, s73, -v13
  v_exp_f32 v16, v16
  v_exp_f32 v17, v17
  v_exp_f32 v18, v18
  v_exp_f32 v19, v19
  v_exp_f32 v20, v20
  v_exp_f32 v21, v21
  v_exp_f32 v22, v22
  v_exp_f32 v23, v23
  s_nop 0
  v_cvt_pk_bf16_f32 v24, v16, v17
  v_cvt_pk_bf16_f32 v25, v18, v19
  v_cvt_pk_bf16_f32 v26, v20, v21
  v_cvt_pk_bf16_f32 v27, v22, v23
  v_add_f32 v14, v14, v16
  v_add_f32 v15, v15, v17
  v_add_f32 v14, v14, v18
  v_add_f32 v15, v15, v19
  v_add_f32 v14, v14, v20
  v_add_f32 v15, v15, v21
  v_add_f32 v14, v14, v22
  v_add_f32 v15, v15, v23
  s_waitcnt vmcnt(24)
  v_perm_b32 v192, v68, v64, s70
  v_perm_b32 v193, v76, v72, s70
  v_perm_b32 v194, v84, v80, s70
  v_perm_b32 v195, v92, v88, s70
  v_perm_b32 v196, v68, v64, s71
  v_perm_b32 v197, v76, v72, s71
  v_perm_b32 v198, v84, v80, s71
  v_perm_b32 v199, v92, v88, s71
  v_perm_b32 v200, v69, v65, s70
  v_perm_b32 v201, v77, v73, s70
  v_perm_b32 v202, v85, v81, s70
  v_perm_b32 v203, v93, v89, s70
  v_perm_b32 v204, v69, v65, s71
  v_perm_b32 v205, v77, v73, s71
  v_perm_b32 v206, v85, v81, s71
  v_perm_b32 v207, v93, v89, s71
  v_perm_b32 v208, v70, v66, s70
  v_perm_b32 v209, v78, v74, s70
  v_perm_b32 v210, v86, v82, s70
  v_perm_b32 v211, v94, v90, s70
  v_perm_b32 v212, v70, v66, s71
  v_perm_b32 v213, v78, v74, s71
  v_perm_b32 v214, v86, v82, s71
  v_perm_b32 v215, v94, v90, s71
  v_perm_b32 v216, v71, v67, s70
  v_perm_b32 v217, v79, v75, s70
  v_perm_b32 v218, v87, v83, s70
  v_perm_b32 v219, v95, v91, s70
  v_perm_b32 v220, v71, v67, s71
  v_perm_b32 v221, v79, v75, s71
  v_perm_b32 v222, v87, v83, s71
  v_perm_b32 v223, v95, v91, s71
  s_nop 1
  v_mfma_f32_16x16x32_bf16 v[224:227], v[192:195], v[24:27], v[224:227]
  v_mfma_f32_16x16x32_bf16 v[228:231], v[196:199], v[24:27], v[228:231]
  v_mfma_f32_16x16x32_bf16 v[232:235], v[200:203], v[24:27], v[232:235]
  v_mfma_f32_16x16x32_bf16 v[236:239], v[204:207], v[24:27], v[236:239]
  v_mfma_f32_16x16x32_bf16 v[240:243], v[208:211], v[24:27], v[240:243]
  v_mfma_f32_16x16x32_bf16 v[244:247], v[212:215], v[24:27], v[244:247]
  v_mfma_f32_16x16x32_bf16 v[248:251], v[216:219], v[24:27], v[248:251]
  v_mfma_f32_16x16x32_bf16 v[252:255], v[220:223], v[24:27], v[252:255]
  buffer_load_dwordx4 v[64:67], v7, s[48:51], s66 offen
  s_add_u32 s66, s66, 8192
  buffer_load_dwordx4 v[68:71], v7, s[48:51], s66 offen
  s_add_u32 s66, s66, 8192
  buffer_load_dwordx4 v[72:75], v7, s[48:51], s66 offen
  s_add_u32 s66, s66, 8192
  buffer_load_dwordx4 v[76:79], v7, s[48:51], s66 offen
  s_add_u32 s66, s66, 8192
  buffer_load_dwordx4 v[80:83], v7, s[48:51], s66 offen
  s_add_u32 s66, s66, 8192
  buffer_load_dwordx4 v[84:87], v7, s[48:51], s66 offen
  s_add_u32 s66, s66, 8192
  buffer_load_dwordx4 v[88:91], v7, s[48:51], s66 offen
  s_add_u32 s66, s66, 8192
  buffer_load_dwordx4 v[92:95], v7, s[48:51], s66 offen
  v_lshlrev_b32 v16, 16, v52
  v_and_b32 v17, 0xffff0000, v52
  v_lshlrev_b32 v18, 16, v53
  v_and_b32 v19, 0xffff0000, v53
  v_lshlrev_b32 v20, 16, v54
  v_and_b32 v21, 0xffff0000, v54
  v_lshlrev_b32 v22, 16, v55
  v_and_b32 v23, 0xffff0000, v55
  v_fma_f32 v16, v16, s73, -v13
  v_fma_f32 v17, v17, s73, -v13
  v_fma_f32 v18, v18, s73, -v13
  v_fma_f32 v19, v19, s73, -v13
  v_fma_f32 v20, v20, s73, -v13
  v_fma_f32 v21, v21, s73, -v13
  v_fma_f32 v22, v22, s73, -v13
  v_fma_f32 v23, v23, s73, -v13
  v_exp_f32 v16, v16
  v_exp_f32 v17, v17
  v_exp_f32 v18, v18
  v_exp_f32 v19, v19
  v_exp_f32 v20, v20
  v_exp_f32 v21, v21
  v_exp_f32 v22, v22
  v_exp_f32 v23, v23
  s_nop 0
  v_cvt_pk_bf16_f32 v24, v16, v17
  v_cvt_pk_bf16_f32 v25, v18, v19
  v_cvt_pk_bf16_f32 v26, v20, v21
  v_cvt_pk_bf16_f32 v27, v22, v23
  v_add_f32 v14, v14, v16
  v_add_f32 v15, v15, v17
  v_add_f32 v14, v14, v18
  v_add_f32 v15, v15, v19
  v_add_f32 v14, v14, v20
  v_add_f32 v15, v15, v21
  v_add_f32 v14, v14, v22
  v_add_f32 v15, v15, v23
  s_waitcnt vmcnt(24)
  v_perm_b32 v192, v100, v96, s70
  v_perm_b32 v193, v108, v104, s70
  v_perm_b32 v194, v116, v112, s70
  v_perm_b32 v195, v124, v120, s70
  v_perm_b32 v196, v100, v96, s71
  v_perm_b32 v197, v108, v104, s71
  v_perm_b32 v198, v116, v112, s71
  v_perm_b32 v199, v124, v120, s71
  v_perm_b32 v200, v101, v97, s70
  v_perm_b32 v201, v109, v105, s70
  v_perm_b32 v202, v117, v113, s70
  v_perm_b32 v203, v125, v121, s70
  v_perm_b32 v204, v101, v97, s71
  v_perm_b32 v205, v109, v105, s71
  v_perm_b32 v206, v117, v113, s71
  v_perm_b32 v207, v125, v121, s71
  v_perm_b32 v208, v102, v98, s70
  v_perm_b32 v209, v110, v106, s70
  v_perm_b32 v210, v118, v114, s70
  v_perm_b32 v211, v126, v122, s70
  v_perm_b32 v212, v102, v98, s71
  v_perm_b32 v213, v110, v106, s71
  v_perm_b32 v214, v118, v114, s71
  v_perm_b32 v215, v126, v122, s71
  v_perm_b32 v216, v103, v99, s70
  v_perm_b32 v217, v111, v107, s70
  v_perm_b32 v218, v119, v115, s70
  v_perm_b32 v219, v127, v123, s70
  v_perm_b32 v220, v103, v99, s71
  v_perm_b32 v221, v111, v107, s71
  v_perm_b32 v222, v119, v115, s71
  v_perm_b32 v223, v127, v123, s71
  s_nop 1
  v_mfma_f32_16x16x32_bf16 v[224:227], v[192:195], v[24:27], v[224:227]
  v_mfma_f32_16x16x32_bf16 v[228:231], v[196:199], v[24:27], v[228:231]
  v_mfma_f32_16x16x32_bf16 v[232:235], v[200:203], v[24:27], v[232:235]
  v_mfma_f32_16x16x32_bf16 v[236:239], v[204:207], v[24:27], v[236:239]
  v_mfma_f32_16x16x32_bf16 v[240:243], v[208:211], v[24:27], v[240:243]
  v_mfma_f32_16x16x32_bf16 v[244:247], v[212:215], v[24:27], v[244:247]
  v_mfma_f32_16x16x32_bf16 v[248:251], v[216:219], v[24:27], v[248:251]
  v_mfma_f32_16x16x32_bf16 v[252:255], v[220:223], v[24:27], v[252:255]
  buffer_load_dwordx4 v[96:99], v7, s[48:51], s67 offen
  s_add_u32 s67, s67, 8192
  buffer_load_dwordx4 v[100:103], v7, s[48:51], s67 offen
  s_add_u32 s67, s67, 8192
  buffer_load_dwordx4 v[104:107], v7, s[48:51], s67 offen
  s_add_u32 s67, s67, 8192
  buffer_load_dwordx4 v[108:111], v7, s[48:51], s67 offen
  s_add_u32 s67, s67, 8192
  buffer_load_dwordx4 v[112:115], v7, s[48:51], s67 offen
  s_add_u32 s67, s67, 8192
  buffer_load_dwordx4 v[116:119], v7, s[48:51], s67 offen
  s_add_u32 s67, s67, 8192
  buffer_load_dwordx4 v[120:123], v7, s[48:51], s67 offen
  s_add_u32 s67, s67, 8192
  buffer_load_dwordx4 v[124:127], v7, s[48:51], s67 offen
  v_lshlrev_b32 v16, 16, v56
  v_and_b32 v17, 0xffff0000, v56
  v_lshlrev_b32 v18, 16, v57
  v_and_b32 v19, 0xffff0000, v57
  v_lshlrev_b32 v20, 16, v58
  v_and_b32 v21, 0xffff0000, v58
  v_lshlrev_b32 v22, 16, v59
  v_and_b32 v23, 0xffff0000, v59
  v_fma_f32 v16, v16, s73, -v13
  v_fma_f32 v17, v17, s73, -v13
  v_fma_f32 v18, v18, s73, -v13
  v_fma_f32 v19, v19, s73, -v13
  v_fma_f32 v20, v20, s73, -v13
  v_fma_f32 v21, v21, s73, -v13
  v_fma_f32 v22, v22, s73, -v13
  v_fma_f32 v23, v23, s73, -v13
  v_exp_f32 v16, v16
  v_exp_f32 v17, v17
  v_exp_f32 v18, v18
  v_exp_f32 v19, v19
  v_exp_f32 v20, v20
  v_exp_f32 v21, v21
  v_exp_f32 v22, v22
  v_exp_f32 v23, v23
  s_nop 0
  v_cvt_pk_bf16_f32 v24, v16, v17
  v_cvt_pk_bf16_f32 v25, v18, v19
  v_cvt_pk_bf16_f32 v26, v20, v21
  v_cvt_pk_bf16_f32 v27, v22, v23
  v_add_f32 v14, v14, v16
  v_add_f32 v15, v15, v17
  v_add_f32 v14, v14, v18
  v_add_f32 v15, v15, v19
  v_add_f32 v14, v14, v20
  v_add_f32 v15, v15, v21
  v_add_f32 v14, v14, v22
  v_add_f32 v15, v15, v23
  s_waitcnt vmcnt(24)
  v_perm_b32 v192, v132, v128, s70
  v_perm_b32 v193, v140, v136, s70
  v_perm_b32 v194, v148, v144, s70
  v_perm_b32 v195, v156, v152, s70
  v_perm_b32 v196, v132, v128, s71
  v_perm_b32 v197, v140, v136, s71
  v_perm_b32 v198, v148, v144, s71
  v_perm_b32 v199, v156, v152, s71
  v_perm_b32 v200, v133, v129, s70
  v_perm_b32 v201, v141, v137, s70
  v_perm_b32 v202, v149, v145, s70
  v_perm_b32 v203, v157, v153, s70
  v_perm_b32 v204, v133, v129, s71
  v_perm_b32 v205, v141, v137, s71
  v_perm_b32 v206, v149, v145, s71
  v_perm_b32 v207, v157, v153, s71
  v_perm_b32 v208, v134, v130, s70
  v_perm_b32 v209, v142, v138, s70
  v_perm_b32 v210, v150, v146, s70
  v_perm_b32 v211, v158, v154, s70
  v_perm_b32 v212, v134, v130, s71
  v_perm_b32 v213, v142, v138, s71
  v_perm_b32 v214, v150, v146, s71
  v_perm_b32 v215, v158, v154, s71
  v_perm_b32 v216, v135, v131, s70
  v_perm_b32 v217, v143, v139, s70
  v_perm_b32 v218, v151, v147, s70
  v_perm_b32 v219, v159, v155, s70
  v_perm_b32 v220, v135, v131, s71
  v_perm_b32 v221, v143, v139, s71
  v_perm_b32 v222, v151, v147, s71
  v_perm_b32 v223, v159, v155, s71
  s_nop 1
  v_mfma_f32_16x16x32_bf16 v[224:227], v[192:195], v[24:27], v[224:227]
  v_mfma_f32_16x16x32_bf16 v[228:231], v[196:199], v[24:27], v[228:231]
  v_mfma_f32_16x16x32_bf16 v[232:235], v[200:203], v[24:27], v[232:235]
  v_mfma_f32_16x16x32_bf16 v[236:239], v[204:207], v[24:27], v[236:239]
  v_mfma_f32_16x16x32_bf16 v[240:243], v[208:211], v[24:27], v[240:243]
  v_mfma_f32_16x16x32_bf16 v[244:247], v[212:215], v[24:27], v[244:247]
  v_mfma_f32_16x16x32_bf16 v[248:251], v[216:219], v[24:27], v[248:251]
  v_mfma_f32_16x16x32_bf16 v[252:255], v[220:223], v[24:27], v[252:255]
  v_lshlrev_b32 v16, 16, v60
  v_and_b32 v17, 0xffff0000, v60
  v_lshlrev_b32 v18, 16, v61
  v_and_b32 v19, 0xffff0000, v61
  v_lshlrev_b32 v20, 16, v62
  v_and_b32 v21, 0xffff0000, v62
  v_lshlrev_b32 v22, 16, v63
  v_and_b32 v23, 0xffff0000, v63
  v_fma_f32 v16, v16, s73, -v13
  v_fma_f32 v17, v17, s73, -v13
  v_fma_f32 v18, v18, s73, -v13
  v_fma_f32 v19, v19, s73, -v13
  v_fma_f32 v20, v20, s73, -v13
  v_fma_f32 v21, v21, s73, -v13
  v_fma_f32 v22, v22, s73, -v13
  v_fma_f32 v23, v23, s73, -v13
  v_exp_f32 v16, v16
  v_exp_f32 v17, v17
  v_exp_f32 v18, v18
  v_exp_f32 v19, v19
  v_exp_f32 v20, v20
  v_exp_f32 v21, v21
  v_exp_f32 v22, v22
  v_exp_f32 v23, v23
  s_nop 0
  v_cvt_pk_bf16_f32 v24, v16, v17
  v_cvt_pk_bf16_f32 v25, v18, v19
  v_cvt_pk_bf16_f32 v26, v20, v21
  v_cvt_pk_bf16_f32 v27, v22, v23
  v_add_f32 v14, v14, v16
  v_add_f32 v15, v15, v17
  v_add_f32 v14, v14, v18
  v_add_f32 v15, v15, v19
  v_add_f32 v14, v14, v20
  v_add_f32 v15, v15, v21
  v_add_f32 v14, v14, v22
  v_add_f32 v15, v15, v23
  s_waitcnt vmcnt(16)
  v_perm_b32 v192, v164, v160, s70
  v_perm_b32 v193, v172, v168, s70
  v_perm_b32 v194, v180, v176, s70
  v_perm_b32 v195, v188, v184, s70
  v_perm_b32 v196, v164, v160, s71
  v_perm_b32 v197, v172, v168, s71
  v_perm_b32 v198, v180, v176, s71
  v_perm_b32 v199, v188, v184, s71
  v_perm_b32 v200, v165, v161, s70
  v_perm_b32 v201, v173, v169, s70
  v_perm_b32 v202, v181, v177, s70
  v_perm_b32 v203, v189, v185, s70
  v_perm_b32 v204, v165, v161, s71
  v_perm_b32 v205, v173, v169, s71
  v_perm_b32 v206, v181, v177, s71
  v_perm_b32 v207, v189, v185, s71
  v_perm_b32 v208, v166, v162, s70
  v_perm_b32 v209, v174, v170, s70
  v_perm_b32 v210, v182, v178, s70
  v_perm_b32 v211, v190, v186, s70
  v_perm_b32 v212, v166, v162, s71
  v_perm_b32 v213, v174, v170, s71
  v_perm_b32 v214, v182, v178, s71
  v_perm_b32 v215, v190, v186, s71
  v_perm_b32 v216, v167, v163, s70
  v_perm_b32 v217, v175, v171, s70
  v_perm_b32 v218, v183, v179, s70
  v_perm_b32 v219, v191, v187, s70
  v_perm_b32 v220, v167, v163, s71
  v_perm_b32 v221, v175, v171, s71
  v_perm_b32 v222, v183, v179, s71
  v_perm_b32 v223, v191, v187, s71
  s_nop 1
  v_mfma_f32_16x16x32_bf16 v[224:227], v[192:195], v[24:27], v[224:227]
  v_mfma_f32_16x16x32_bf16 v[228:231], v[196:199], v[24:27], v[228:231]
  v_mfma_f32_16x16x32_bf16 v[232:235], v[200:203], v[24:27], v[232:235]
  v_mfma_f32_16x16x32_bf16 v[236:239], v[204:207], v[24:27], v[236:239]
  v_mfma_f32_16x16x32_bf16 v[240:243], v[208:211], v[24:27], v[240:243]
  v_mfma_f32_16x16x32_bf16 v[244:247], v[212:215], v[24:27], v[244:247]
  v_mfma_f32_16x16x32_bf16 v[248:251], v[216:219], v[24:27], v[248:251]
  v_mfma_f32_16x16x32_bf16 v[252:255], v[220:223], v[24:27], v[252:255]
  v_add_f32 v14, v14, v15
  v_xor_b32 v9, 64, v8
  ds_bpermute_b32 v15, v9, v14
  s_waitcnt lgkmcnt(0)
  v_add_f32 v14, v14, v15
  v_xor_b32 v9, 128, v8
  ds_bpermute_b32 v15, v9, v14
  s_waitcnt lgkmcnt(0)
  v_add_f32 v14, v14, v15
  v_lshlrev_b32 v9, 6, v3
  v_lshl_add_u32 v9, v4, 4, v9
  s_lshl_b32 s84, s60, 11
  v_add_u32 v9, s84, v9
  v_lshlrev_b32 v10, 3, v3
  s_lshl_b32 s84, s60, 5
  v_add_u32 v10, s84, v10
  v_mov_b32 v13, v14
  v_cmp_gt_u32 vcc, 4, v3
  s_and_saveexec_b64 s[80:81], vcc
  ds_write_b128 v9, v[224:227] offset:0
  ds_write_b128 v9, v[228:231] offset:256
  ds_write_b128 v9, v[232:235] offset:512
  ds_write_b128 v9, v[236:239] offset:768
  ds_write_b128 v9, v[240:243] offset:1024
  ds_write_b128 v9, v[244:247] offset:1280
  ds_write_b128 v9, v[248:251] offset:1536
  ds_write_b128 v9, v[252:255] offset:1792
  ds_write_b64 v10, v[12:13] offset:32768
  s_mov_b64 exec, s[80:81]
  s_waitcnt lgkmcnt(0)
  s_barrier
  s_cmp_ge_u32 s60, 2
  s_cbranch_scc1 L_comb_done
  v_lshrrev_b32 v10, 5, v0
  v_bfe_u32 v11, v0, 2, 3
  v_and_b32 v9, 3, v0
  v_lshlrev_b32 v9, 4, v9
  v_lshl_add_u32 v9, v10, 6, v9
  v_lshl_add_u32 v9, v11, 8, v9
  ds_read_b128 v[192:195], v9 offset:0
  ds_read_b128 v[196:199], v9 offset:2048
  ds_read_b128 v[200:203], v9 offset:4096
  ds_read_b128 v[204:207], v9 offset:6144
  ds_read_b128 v[208:211], v9 offset:8192
  ds_read_b128 v[212:215], v9 offset:10240
  ds_read_b128 v[216:219], v9 offset:12288
  ds_read_b128 v[220:223], v9 offset:14336
  v_lshlrev_b32 v11, 3, v10
  ds_read_b64 v[32:33], v11 offset:32768
  ds_read_b64 v[34:35], v11 offset:32800
  ds_read_b64 v[36:37], v11 offset:32832
  ds_read_b64 v[38:39], v11 offset:32864
  ds_read_b64 v[40:41], v11 offset:32896
  ds_read_b64 v[42:43], v11 offset:32928
  ds_read_b64 v[44:45], v11 offset:32960
  ds_read_b64 v[46:47], v11 offset:32992
  s_waitcnt lgkmcnt(0)
  v_max3_f32 v12, v32, v34, v36
  v_max3_f32 v12, v12, v38, v40
  v_max3_f32 v12, v12, v42, v44
  v_max_f32 v12, v12, v46
  v_sub_f32 v48, v32, v12
  v_sub_f32 v49, v34, v12
  v_sub_f32 v50, v36, v12
  v_sub_f32 v51, v38, v12
  v_sub_f32 v52, v40, v12
  v_sub_f32 v53, v42, v12
  v_sub_f32 v54, v44, v12
  v_sub_f32 v55, v46, v12
  v_mul_f32 v48, s73, v48
  v_mul_f32 v49, s73, v49
  v_mul_f32 v50, s73, v50
  v_mul_f32 v51, s73, v51
  v_mul_f32 v52, s73, v52
  v_mul_f32 v53, s73, v53
  v_mul_f32 v54, s73, v54
  v_mul_f32 v55, s73, v55
  v_exp_f32 v48, v48
  v_exp_f32 v49, v49
  v_exp_f32 v50, v50
  v_exp_f32 v51, v51
  v_exp_f32 v52, v52
  v_exp_f32 v53, v53
  v_exp_f32 v54, v54
  v_exp_f32 v55, v55
  s_nop 0
  v_mul_f32 v16, v48, v192
  v_mul_f32 v17, v48, v193
  v_mul_f32 v18, v48, v194
  v_mul_f32 v19, v48, v195
  v_mul_f32 v13, v48, v33
  v_fmac_f32 v16, v49, v196
  v_fmac_f32 v17, v49, v197
  v_fmac_f32 v18, v49, v198
  v_fmac_f32 v19, v49, v199
  v_fmac_f32 v13, v49, v35
  v_fmac_f32 v16, v50, v200
  v_fmac_f32 v17, v50, v201
  v_fmac_f32 v18, v50, v202
  v_fmac_f32 v19, v50, v203
  v_fmac_f32 v13, v50, v37
  v_fmac_f32 v16, v51, v204
  v_fmac_f32 v17, v51, v205
  v_fmac_f32 v18, v51, v206
  v_fmac_f32 v19, v51, v207
  v_fmac_f32 v13, v51, v39
  v_fmac_f32 v16, v52, v208
  v_fmac_f32 v17, v52, v209
  v_fmac_f32 v18, v52, v210
  v_fmac_f32 v19, v52, v211
  v_fmac_f32 v13, v52, v41
  v_fmac_f32 v16, v53, v212
  v_fmac_f32 v17, v53, v213
  v_fmac_f32 v18, v53, v214
  v_fmac_f32 v19, v53, v215
  v_fmac_f32 v13, v53, v43
  v_fmac_f32 v16, v54, v216
  v_fmac_f32 v17, v54, v217
  v_fmac_f32 v18, v54, v218
  v_fmac_f32 v19, v54, v219
  v_fmac_f32 v13, v54, v45
  v_fmac_f32 v16, v55, v220
  v_fmac_f32 v17, v55, v221
  v_fmac_f32 v18, v55, v222
  v_fmac_f32 v19, v55, v223
  v_fmac_f32 v13, v55, v47
  v_lshlrev_b32 v9, 4, v0
  s_lshl_b32 s84, s2, 11
  s_add_u32 s84, s84, 0x200000
  buffer_store_dwordx4 v[16:19], v9, s[36:39], s84 offen sc1
  v_and_b32 v9, 31, v0
  v_cmp_eq_u32 vcc, 0, v9
  s_lshl_b32 s84, s2, 5
  s_add_u32 s84, s84, 0x280000
  s_and_saveexec_b64 s[80:81], vcc
  buffer_store_dwordx2 v[12:13], v11, s[36:39], s84 offen sc1
  s_mov_b64 exec, s[80:81]
  s_waitcnt vmcnt(0)
L_comb_done:
  s_barrier
  s_cmp_lg_u32 s60, 0
  s_cbranch_scc1 L_noflag
  s_lshl_b32 s89, s2, 7
  s_add_u32 s89, s89, 0x390000
  v_mov_b32 v8, s89
  v_mov_b32 v9, s91
  s_mov_b64 s[80:81], exec
  s_mov_b64 exec, 1
  buffer_store_dword v9, v8, s[36:39], 0 offen sc1
  s_mov_b64 exec, s[80:81]
L_noflag:
  s_cmp_eq_u32 s65, 0
  s_cbranch_scc1 L_end
  s_cmp_eq_u32 s65, 3
  s_cbranch_scc1 L_final
  s_waitcnt vmcnt(0)
  v_perm_b32 v128, v68, v64, s70
  v_perm_b32 v129, v76, v72, s70
  v_perm_b32 v130, v84, v80, s70
  v_perm_b32 v131, v92, v88, s70
  v_perm_b32 v132, v68, v64, s71
  v_perm_b32 v133, v76, v72, s71
  v_perm_b32 v134, v84, v80, s71
  v_perm_b32 v135, v92, v88, s71
  v_perm_b32 v136, v69, v65, s70
  v_perm_b32 v137, v77, v73, s70
  v_perm_b32 v138, v85, v81, s70
  v_perm_b32 v139, v93, v89, s70
  v_perm_b32 v140, v69, v65, s71
  v_perm_b32 v141, v77, v73, s71
  v_perm_b32 v142, v85, v81, s71
  v_perm_b32 v143, v93, v89, s71
  v_perm_b32 v144, v70, v66, s70
  v_perm_b32 v145, v78, v74, s70
  v_perm_b32 v146, v86, v82, s70
  v_perm_b32 v147, v94, v90, s70
  v_perm_b32 v148, v70, v66, s71
  v_perm_b32 v149, v78, v74, s71
  v_perm_b32 v150, v86, v82, s71
  v_perm_b32 v151, v94, v90, s71
  v_perm_b32 v152, v71, v67, s70
  v_perm_b32 v153, v79, v75, s70
  v_perm_b32 v154, v87, v83, s70
  v_perm_b32 v155, v95, v91, s70
  v_perm_b32 v156, v71, v67, s71
  v_perm_b32 v157, v79, v75, s71
  v_perm_b32 v158, v87, v83, s71
  v_perm_b32 v159, v95, v91, s71
  v_perm_b32 v160, v100, v96, s70
  v_perm_b32 v161, v108, v104, s70
  v_perm_b32 v162, v116, v112, s70
  v_perm_b32 v163, v124, v120, s70
  v_perm_b32 v164, v100, v96, s71
  v_perm_b32 v165, v108, v104, s71
  v_perm_b32 v166, v116, v112, s71
  v_perm_b32 v167, v124, v120, s71
  v_perm_b32 v168, v101, v97, s70
  v_perm_b32 v169, v109, v105, s70
  v_perm_b32 v170, v117, v113, s70
  v_perm_b32 v171, v125, v121, s70
  v_perm_b32 v172, v101, v97, s71
  v_perm_b32 v173, v109, v105, s71
  v_perm_b32 v174, v117, v113, s71
  v_perm_b32 v175, v125, v121, s71
  v_perm_b32 v176, v102, v98, s70
  v_perm_b32 v177, v110, v106, s70
  v_perm_b32 v178, v118, v114, s70
  v_perm_b32 v179, v126, v122, s70
  v_perm_b32 v180, v102, v98, s71
  v_perm_b32 v181, v110, v106, s71
  v_perm_b32 v182, v118, v114, s71
  v_perm_b32 v183, v126, v122, s71
  v_perm_b32 v184, v103, v99, s70
  v_perm_b32 v185, v111, v107, s70
  v_perm_b32 v186, v119, v115, s70
  v_perm_b32 v187, v127, v123, s70
  v_perm_b32 v188, v103, v99, s71
  v_perm_b32 v189, v111, v107, s71
  v_perm_b32 v190, v119, v115, s71
  v_perm_b32 v191, v127, v123, s71
  s_cmp_lg_u32 s60, 0
  s_cbranch_scc1 L_t_wait
  s_cmp_eq_u32 s65, 2
  s_cbranch_scc1 L_t_pollf
  v_bfe_u32 v11, v1, 2, 3
  v_lshlrev_b32 v11, 5, v11
  v_and_b32 v12, 3, v1
  v_add_u32 v11, v11, v12
  s_lshr_b32 s89, s68, 2
  s_lshl_b32 s89, s89, 2
  v_add_u32 v11, s89, v11
  v_lshlrev_b32 v11, 7, v11
  v_add_u32 v11, 0x390000, v11
  s_mov_b64 s[92:93], exec
  s_mov_b32 s82, 100000
  buffer_load_dword v8, v11, s[36:39], 0 offen sc1
L_poll2:
  s_sleep 1
  buffer_load_dword v9, v11, s[36:39], 0 offen sc1
  s_waitcnt vmcnt(1)
  v_cmp_ne_u32 vcc, s91, v8
  s_and_b64 vcc, vcc, s[92:93]
  s_cbranch_scc0 L_poll2_done
  s_sleep 1
  buffer_load_dword v8, v11, s[36:39], 0 offen sc1
  s_waitcnt vmcnt(1)
  v_cmp_ne_u32 vcc, s91, v9
  s_and_b64 vcc, vcc, s[92:93]
  s_cbranch_scc0 L_poll2_done
  s_sub_u32 s82, s82, 1
  s_cmp_eq_u32 s82, 0
  s_cbranch_scc0 L_poll2
L_poll2_done:
  s_waitcnt vmcnt(0)
  s_branch L_t_wait
L_t_pollf:
  v_lshlrev_b32 v11, 7, v1
  v_add_u32 v11, 0x3b0000, v11
  s_mov_b64 s[92:93], exec
  s_mov_b32 s82, 100000
  buffer_load_dword v8, v11, s[36:39], 0 offen sc1
L_poll3:
  s_sleep 1
  buffer_load_dword v9, v11, s[36:39], 0 offen sc1
  s_waitcnt vmcnt(1)
  v_cmp_ne_u32 vcc, s91, v8
  s_and_b64 vcc, vcc, s[92:93]
  s_cbranch_scc0 L_poll3_done
  s_sleep 1
  buffer_load_dword v8, v11, s[36:39], 0 offen sc1
  s_waitcnt vmcnt(1)
  v_cmp_ne_u32 vcc, s91, v9
  s_and_b64 vcc, vcc, s[92:93]
  s_cbranch_scc0 L_poll3_done
  s_sub_u32 s82, s82, 1
  s_cmp_eq_u32 s82, 0
  s_cbranch_scc0 L_poll3
L_poll3_done:
  s_waitcnt vmcnt(0)
  v_add_u32 v11, 8192, v11
  s_mov_b32 s82, 100000
  buffer_load_dword v8, v11, s[36:39], 0 offen sc1
L_poll4:
  s_sleep 1
  buffer_load_dword v9, v11, s[36:39], 0 offen sc1
  s_waitcnt vmcnt(1)
  v_cmp_ne_u32 vcc, s91, v8
  s_and_b64 vcc, vcc, s[92:93]
  s_cbranch_scc0 L_poll4_done
  s_sleep 1
  buffer_load_dword v8, v11, s[36:39], 0 offen sc1
  s_waitcnt vmcnt(1)
  v_cmp_ne_u32 vcc, s91, v9
  s_and_b64 vcc, vcc, s[92:93]
  s_cbranch_scc0 L_poll4_done
  s_sub_u32 s82, s82, 1
  s_cmp_eq_u32 s82, 0
  s_cbranch_scc0 L_poll4
L_poll4_done:
  s_waitcnt vmcnt(0)
  v_add_u32 v11, 8192, v11
  s_mov_b32 s82, 100000
  buffer_load_dword v8, v11, s[36:39], 0 offen sc1
L_poll5:
  s_sleep 1
  buffer_load_dword v9, v11, s[36:39], 0 offen sc1
  s_waitcnt vmcnt(1)
  v_cmp_ne_u32 vcc, s91, v8
  s_and_b64 vcc, vcc, s[92:93]
  s_cbranch_scc0 L_poll5_done
  s_sleep 1
  buffer_load_dword v8, v11, s[36:39], 0 offen sc1
  s_waitcnt vmcnt(1)
  v_cmp_ne_u32 vcc, s91, v9
  s_and_b64 vcc, vcc, s[92:93]
  s_cbranch_scc0 L_poll5_done
  s_sub_u32 s82, s82, 1
  s_cmp_eq_u32 s82, 0
  s_cbranch_scc0 L_poll5
L_poll5_done:
  s_waitcnt vmcnt(0)
  v_add_u32 v11, 8192, v11
  s_mov_b32 s93, 0
  s_mov_b32 s82, 100000
  buffer_load_dword v8, v11, s[36:39], 0 offen sc1
L_poll6:
  s_sleep 1
  buffer_load_dword v9, v11, s[36:39], 0 offen sc1
  s_waitcnt vmcnt(1)
  v_cmp_ne_u32 vcc, s91, v8
  s_and_b64 vcc, vcc, s[92:93]
  s_cbranch_scc0 L_poll6_done
  s_sleep 1
  buffer_load_dword v8, v11, s[36:39], 0 offen sc1
  s_waitcnt vmcnt(1)
  v_cmp_ne_u32 vcc, s91, v9
  s_and_b64 vcc, vcc, s[92:93]
  s_cbranch_scc0 L_poll6_done
  s_sub_u32 s82, s82, 1
  s_cmp_eq_u32 s82, 0
  s_cbranch_scc0 L_poll6
L_poll6_done:
  s_waitcnt vmcnt(0)
L_t_wait:
  s_barrier
  s_cmp_ge_u32 s60, 4
  s_cbranch_scc1 L_t_bdone
  v_lshrrev_b32 v10, 5, v0
  v_and_b32 v11, 31, v0
  s_cmp_eq_u32 s65, 2
  s_cbranch_scc1 L_t_down
  v_lshlrev_b32 v12, 16, v10
  v_lshl_add_u32 v12, v11, 4, v12
  s_lshr_b32 s84, s68, 2
  s_and_b32 s85, s68, 3
  s_lshl_b32 s86, s84, 13
  s_lshl_b32 s87, s85, 9
  s_add_u32 s86, s86, s87
  s_add_u32 s86, s86, 0x200000
  buffer_load_dwordx4 v[64:67], v12, s[36:39], s86 offen offset:0 sc1
  buffer_load_dwordx4 v[68:71], v12, s[36:39], s86 offen offset:2048 sc1
  s_add_u32 s86, s86, 4096
  buffer_load_dwordx4 v[72:75], v12, s[36:39], s86 offen offset:0 sc1
  buffer_load_dwordx4 v[76:79], v12, s[36:39], s86 offen offset:2048 sc1
  v_lshlrev_b32 v12, 10, v10
  s_lshl_b32 s86, s84, 7
  s_lshl_b32 s87, s85, 3
  s_add_u32 s86, s86, s87
  s_add_u32 s86, s86, 0x280000
  buffer_load_dwordx2 v[32:33], v12, s[36:39], s86 offen offset:0 sc1
  buffer_load_dwordx2 v[34:35], v12, s[36:39], s86 offen offset:32 sc1
  buffer_load_dwordx2 v[36:37], v12, s[36:39], s86 offen offset:64 sc1
  buffer_load_dwordx2 v[38:39], v12, s[36:39], s86 offen offset:96 sc1
  s_waitcnt vmcnt(0)
  v_max3_f32 v12, v32, v34, v36
  v_max_f32 v12, v12, v38
  v_sub_f32 v40, v32, v12
  v_sub_f32 v41, v34, v12
  v_sub_f32 v42, v36, v12
  v_sub_f32 v43, v38, v12
  v_mul_f32 v40, s73, v40
  v_mul_f32 v41, s73, v41
  v_mul_f32 v42, s73, v42
  v_mul_f32 v43, s73, v43
  v_exp_f32 v40, v40
  v_exp_f32 v41, v41
  v_exp_f32 v42, v42
  v_exp_f32 v43, v43
  s_nop 0
  v_mul_f32 v13, v40, v33
  v_fmac_f32 v13, v41, v35
  v_fmac_f32 v13, v42, v37
  v_fmac_f32 v13, v43, v39
  v_mul_f32 v44, v40, v64
  v_mul_f32 v45, v40, v65
  v_mul_f32 v46, v40, v66
  v_mul_f32 v47, v40, v67
  v_fmac_f32 v44, v41, v68
  v_fmac_f32 v45, v41, v69
  v_fmac_f32 v46, v41, v70
  v_fmac_f32 v47, v41, v71
  v_fmac_f32 v44, v42, v72
  v_fmac_f32 v45, v42, v73
  v_fmac_f32 v46, v42, v74
  v_fmac_f32 v47, v42, v75
  v_fmac_f32 v44, v43, v76
  v_fmac_f32 v45, v43, v77
  v_fmac_f32 v46, v43, v78
  v_fmac_f32 v47, v43, v79
  v_rcp_f32 v12, v13
  s_nop 0
  v_mul_f32 v64, v44, v12
  v_mul_f32 v65, v45, v12
  v_mul_f32 v66, v46, v12
  v_mul_f32 v67, v47, v12
  v_fma_f32 v80, -v64, v13, v44
  v_fma_f32 v81, -v65, v13, v45
  v_fma_f32 v82, -v66, v13, v46
  v_fma_f32 v83, -v67, v13, v47
  v_fma_f32 v64, v80, v12, v64
  v_fma_f32 v65, v81, v12, v65
  v_fma_f32 v66, v82, v12, v66
  v_fma_f32 v67, v83, v12, v67
  v_cvt_pk_bf16_f32 v16, v64, v65
  v_cvt_pk_bf16_f32 v17, v66, v67
  s_branch L_t_bst
L_t_down:
  v_lshlrev_b32 v12, 9, v10
  v_lshl_add_u32 v12, v11, 4, v12
  s_lshl_b32 s84, s68, 12
  s_add_u32 s84, s84, 0x100000
  s_add_u32 s85, s84, 57344
  buffer_load_dwordx4 v[32:35], v12, s[36:39], s84 offen sc1
  buffer_load_dwordx4 v[64:67], v12, s[36:39], s85 offen sc1
  s_add_u32 s84, s84, 114688
  s_add_u32 s85, s85, 114688
  buffer_load_dwordx4 v[36:39], v12, s[36:39], s84 offen sc1
  buffer_load_dwordx4 v[68:71], v12, s[36:39], s85 offen sc1
  s_add_u32 s84, s84, 114688
  s_add_u32 s85, s85, 114688
  buffer_load_dwordx4 v[40:43], v12, s[36:39], s84 offen sc1
  buffer_load_dwordx4 v[72:75], v12, s[36:39], s85 offen sc1
  s_add_u32 s84, s84, 114688
  s_add_u32 s85, s85, 114688
  buffer_load_dwordx4 v[44:47], v12, s[36:39], s84 offen sc1
  buffer_load_dwordx4 v[76:79], v12, s[36:39], s85 offen sc1
  s_add_u32 s84, s84, 114688
  s_add_u32 s85, s85, 114688
  buffer_load_dwordx4 v[48:51], v12, s[36:39], s84 offen sc1
  buffer_load_dwordx4 v[80:83], v12, s[36:39], s85 offen sc1
  s_add_u32 s84, s84, 114688
  s_add_u32 s85, s85, 114688
  buffer_load_dwordx4 v[52:55], v12, s[36:39], s84 offen sc1
  buffer_load_dwordx4 v[84:87], v12, s[36:39], s85 offen sc1
  s_add_u32 s84, s84, 114688
  s_add_u32 s85, s85, 114688
  buffer_load_dwordx4 v[56:59], v12, s[36:39], s84 offen sc1
  buffer_load_dwordx4 v[88:91], v12, s[36:39], s85 offen sc1
  s_add_u32 s84, s84, 114688
  s_add_u32 s85, s85, 114688
  buffer_load_dwordx4 v[60:63], v12, s[36:39], s84 offen sc1
  buffer_load_dwordx4 v[92:95], v12, s[36:39], s85 offen sc1
  s_waitcnt vmcnt(0)
  v_add_f32 v32, v32, v36
  v_add_f32 v40, v40, v44
  v_add_f32 v48, v48, v52
  v_add_f32 v56, v56, v60
  v_add_f32 v33, v33, v37
  v_add_f32 v41, v41, v45
  v_add_f32 v49, v49, v53
  v_add_f32 v57, v57, v61
  v_add_f32 v34, v34, v38
  v_add_f32 v42, v42, v46
  v_add_f32 v50, v50, v54
  v_add_f32 v58, v58, v62
  v_add_f32 v35, v35, v39
  v_add_f32 v43, v43, v47
  v_add_f32 v51, v51, v55
  v_add_f32 v59, v59, v63
  v_add_f32 v32, v32, v40
  v_add_f32 v48, v48, v56
  v_add_f32 v33, v33, v41
  v_add_f32 v49, v49, v57
  v_add_f32 v34, v34, v42
  v_add_f32 v50, v50, v58
  v_add_f32 v35, v35, v43
  v_add_f32 v51, v51, v59
  v_add_f32 v32, v32, v48
  v_add_f32 v33, v33, v49
  v_add_f32 v34, v34, v50
  v_add_f32 v35, v35, v51
  v_add_f32 v64, v64, v68
  v_add_f32 v72, v72, v76
  v_add_f32 v80, v80, v84
  v_add_f32 v88, v88, v92
  v_add_f32 v65, v65, v69
  v_add_f32 v73, v73, v77
  v_add_f32 v81, v81, v85
  v_add_f32 v89, v89, v93
  v_add_f32 v66, v66, v70
  v_add_f32 v74, v74, v78
  v_add_f32 v82, v82, v86
  v_add_f32 v90, v90, v94
  v_add_f32 v67, v67, v71
  v_add_f32 v75, v75, v79
  v_add_f32 v83, v83, v87
  v_add_f32 v91, v91, v95
  v_add_f32 v64, v64, v72
  v_add_f32 v80, v80, v88
  v_add_f32 v65, v65, v73
  v_add_f32 v81, v81, v89
  v_add_f32 v66, v66, v74
  v_add_f32 v82, v82, v90
  v_add_f32 v67, v67, v75
  v_add_f32 v83, v83, v91
  v_add_f32 v64, v64, v80
  v_add_f32 v65, v65, v81
  v_add_f32 v66, v66, v82
  v_add_f32 v67, v67, v83
  v_cvt_pk_bf16_f32 v40, v32, v64
  v_cvt_pk_bf16_f32 v41, v33, v65
  v_cvt_pk_bf16_f32 v42, v34, v66
  v_cvt_pk_bf16_f32 v43, v35, v67
  v_lshlrev_b32 v32, 16, v40
  v_and_b32 v64, 0xffff0000, v40
  v_lshlrev_b32 v33, 16, v41
  v_and_b32 v65, 0xffff0000, v41
  v_lshlrev_b32 v34, 16, v42
  v_and_b32 v66, 0xffff0000, v42
  v_lshlrev_b32 v35, 16, v43
  v_and_b32 v67, 0xffff0000, v43
  v_max_f32 v32, 0, v32
  v_max_f32 v33, 0, v33
  v_max_f32 v34, 0, v34
  v_max_f32 v35, 0, v35
  v_mul_f32 v32, v32, v64
  v_mul_f32 v33, v33, v65
  v_mul_f32 v34, v34, v66
  v_mul_f32 v35, v35, v67
  v_cvt_pk_bf16_f32 v16, v32, v33
  v_cvt_pk_bf16_f32 v17, v34, v35
L_t_bst:
  v_lshlrev_b32 v12, 3, v0
  ds_write_b64 v12, v[16:17] offset:34048
  s_waitcnt lgkmcnt(0)
L_t_bdone:
  s_barrier
  v_and_b32 v10, 7, v3
  v_lshlrev_b32 v10, 8, v10
  v_lshl_add_u32 v10, v4, 4, v10
  s_and_b32 s84, s60, 1
  s_lshl_b32 s84, s84, 7
  v_add_u32 v10, s84, v10
  ds_read_b128 v[16:19], v10 offset:34048
  ds_read_b128 v[20:23], v10 offset:34112
  s_waitcnt lgkmcnt(0)
  v_mfma_f32_16x16x32_bf16 v[224:227], v[128:131], v[16:19], 0
  v_mfma_f32_16x16x32_bf16 v[228:231], v[132:135], v[16:19], 0
  v_mfma_f32_16x16x32_bf16 v[232:235], v[136:139], v[16:19], 0
  v_mfma_f32_16x16x32_bf16 v[236:239], v[140:143], v[16:19], 0
  v_mfma_f32_16x16x32_bf16 v[240:243], v[144:147], v[16:19], 0
  v_mfma_f32_16x16x32_bf16 v[244:247], v[148:151], v[16:19], 0
  v_mfma_f32_16x16x32_bf16 v[248:251], v[152:155], v[16:19], 0
  v_mfma_f32_16x16x32_bf16 v[252:255], v[156:159], v[16:19], 0
  v_mfma_f32_16x16x32_bf16 v[224:227], v[160:163], v[20:23], v[224:227]
  v_mfma_f32_16x16x32_bf16 v[228:231], v[164:167], v[20:23], v[228:231]
  v_mfma_f32_16x16x32_bf16 v[232:235], v[168:171], v[20:23], v[232:235]
  v_mfma_f32_16x16x32_bf16 v[236:239], v[172:175], v[20:23], v[236:239]
  v_mfma_f32_16x16x32_bf16 v[240:243], v[176:179], v[20:23], v[240:243]
  v_mfma_f32_16x16x32_bf16 v[244:247], v[180:183], v[20:23], v[244:247]
  v_mfma_f32_16x16x32_bf16 v[248:251], v[184:187], v[20:23], v[248:251]
  v_mfma_f32_16x16x32_bf16 v[252:255], v[188:191], v[20:23], v[252:255]
  v_lshlrev_b32 v9, 6, v3
  v_lshl_add_u32 v9, v4, 4, v9
  s_lshl_b32 s84, s60, 12
  v_add_u32 v9, s84, v9
  v_cmp_gt_u32 vcc, 8, v3
  s_and_saveexec_b64 s[80:81], vcc
  s_nop 7
  ds_write_b128 v9, v[224:227] offset:0
  ds_write_b128 v9, v[228:231] offset:512
  ds_write_b128 v9, v[232:235] offset:1024
  ds_write_b128 v9, v[236:239] offset:1536
  ds_write_b128 v9, v[240:243] offset:2048
  ds_write_b128 v9, v[244:247] offset:2560
  ds_write_b128 v9, v[248:251] offset:3072
  ds_write_b128 v9, v[252:255] offset:3584
  s_mov_b64 exec, s[80:81]
  s_waitcnt lgkmcnt(0)
  s_barrier
  v_and_b32 v9, 255, v0
  v_lshlrev_b32 v9, 4, v9
  v_lshrrev_b32 v13, 8, v0
  v_lshl_add_u32 v9, v13, 14, v9
  ds_read_b128 v[64:67], v9 offset:0
  ds_read_b128 v[68:71], v9 offset:4096
  ds_read_b128 v[72:75], v9 offset:8192
  ds_read_b128 v[76:79], v9 offset:12288
  v_bfe_u32 v10, v0, 5, 3
  v_bfe_u32 v11, v0, 2, 3
  v_and_b32 v12, 3, v0
  v_lshlrev_b32 v11, 11, v11
  v_lshl_add_u32 v11, v10, 6, v11
  v_lshl_add_u32 v11, v12, 4, v11
  v_lshl_add_u32 v11, v13, 10, v11
  s_mov_b32 s84, s68
  s_cmp_eq_u32 s65, 2
  s_cselect_b32 s85, 32, 0
  s_add_u32 s84, s84, s85
  s_lshl_b32 s84, s84, 14
  s_add_u32 s84, s84, 0x290000
  s_waitcnt lgkmcnt(0)
  v_add_f32 v64, v64, v68
  v_add_f32 v72, v72, v76
  v_add_f32 v65, v65, v69
  v_add_f32 v73, v73, v77
  v_add_f32 v66, v66, v70
  v_add_f32 v74, v74, v78
  v_add_f32 v67, v67, v71
  v_add_f32 v75, v75, v79
  buffer_store_dwordx4 v[64:67], v11, s[36:39], s84 offen sc1
  buffer_store_dwordx4 v[72:75], v11, s[36:39], s84 offen offset:512 sc1
  s_waitcnt vmcnt(0)
  s_barrier
  s_cmp_lg_u32 s60, 0
  s_cbranch_scc1 L_end
  s_mov_b32 s90, s68
  s_cmp_eq_u32 s65, 2
  s_cselect_b32 s85, 32, 0
  s_add_u32 s90, s90, s85
  s_lshl_b32 s89, s90, 7
  s_add_u32 s89, s89, 0x3a0000
  v_mov_b32 v8, s89
  v_mov_b32 v9, s91
  s_mov_b64 s[80:81], exec
  s_mov_b64 exec, 1
  buffer_store_dword v9, v8, s[36:39], 0 offen sc1
  s_mov_b64 exec, s[80:81]
  s_branch L_end
L_final:
  s_cmp_lg_u32 s60, 0
  s_cbranch_scc1 L_f_wait
  v_lshlrev_b32 v11, 7, v1
  v_add_u32 v11, 0x3a0000, v11
  s_mov_b32 s92, 0xffffffff
  s_mov_b32 s93, 0x00003fff
  s_mov_b32 s82, 100000
  buffer_load_dword v8, v11, s[36:39], 0 offen sc1
L_poll7:
  s_sleep 1
  buffer_load_dword v9, v11, s[36:39], 0 offen sc1
  s_waitcnt vmcnt(1)
  v_cmp_ne_u32 vcc, s91, v8
  s_and_b64 vcc, vcc, s[92:93]
  s_cbranch_scc0 L_poll7_done
  s_sleep 1
  buffer_load_dword v8, v11, s[36:39], 0 offen sc1
  s_waitcnt vmcnt(1)
  v_cmp_ne_u32 vcc, s91, v9
  s_and_b64 vcc, vcc, s[92:93]
  s_cbranch_scc0 L_poll7_done
  s_sub_u32 s82, s82, 1
  s_cmp_eq_u32 s82, 0
  s_cbranch_scc0 L_poll7
L_poll7_done:
  s_waitcnt vmcnt(0)
L_f_wait:
  s_barrier
  v_lshrrev_b32 v10, 5, v0
  v_and_b32 v11, 31, v0
  v_lshlrev_b32 v12, 14, v10
  v_lshl_add_u32 v12, v11, 4, v12
  s_lshl_b32 s84, s68, 9
  s_add_u32 s84, s84, 0x290000
  buffer_load_dwordx4 v[64:67], v12, s[36:39], s84 offen sc1
  s_add_u32 s85, s84, 262144
  buffer_load_dwordx4 v[68:71], v12, s[36:39], s85 offen sc1
  s_add_u32 s85, s84, 524288
  v_mov_b32 v72, 0
  v_mov_b32 v73, 0
  v_mov_b32 v74, 0
  v_mov_b32 v75, 0
  v_cmp_gt_u32 vcc, 14, v10
  s_and_saveexec_b64 s[80:81], vcc
  buffer_load_dwordx4 v[72:75], v12, s[36:39], s85 offen sc1
  s_mov_b64 exec, s[80:81]
  v_lshrrev_b32 v13, 2, v11
  v_and_b32 v14, 3, v11
  v_lshl_add_u32 v13, v14, 5, v13
  v_lshlrev_b32 v13, 1, v13
  s_lshl_b32 s86, s68, 8
  buffer_load_ushort v16, v13, s[44:47], s86 offen offset:0
  buffer_load_ushort v17, v13, s[44:47], s86 offen offset:16
  buffer_load_ushort v18, v13, s[44:47], s86 offen offset:32
  buffer_load_ushort v19, v13, s[44:47], s86 offen offset:48
  s_waitcnt vmcnt(0)
  v_add_f32 v64, v64, v68
  v_add_f32 v65, v65, v69
  v_add_f32 v66, v66, v70
  v_add_f32 v67, v67, v71
  v_lshlrev_b32 v9, 4, v0
  ds_write_b128 v9, v[64:67] offset:0
  ds_write_b128 v9, v[72:75] offset:8192
  s_waitcnt lgkmcnt(0)
  s_barrier
  s_cmp_lg_u32 s60, 0
  s_cbranch_scc1 L_end
  v_lshrrev_b32 v9, 5, v1
  v_lshlrev_b32 v9, 13, v9
  v_lshl_add_u32 v9, v11, 4, v9
  ds_read_b128 v[64:67], v9 offset:0
  ds_read_b128 v[68:71], v9 offset:512
  ds_read_b128 v[72:75], v9 offset:1024
  ds_read_b128 v[76:79], v9 offset:1536
  ds_read_b128 v[80:83], v9 offset:2048
  ds_read_b128 v[84:87], v9 offset:2560
  ds_read_b128 v[88:91], v9 offset:3072
  ds_read_b128 v[92:95], v9 offset:3584
  ds_read_b128 v[96:99], v9 offset:4096
  ds_read_b128 v[100:103], v9 offset:4608
  ds_read_b128 v[104:107], v9 offset:5120
  ds_read_b128 v[108:111], v9 offset:5632
  ds_read_b128 v[112:115], v9 offset:6144
  ds_read_b128 v[116:119], v9 offset:6656
  ds_read_b128 v[120:123], v9 offset:7168
  ds_read_b128 v[124:127], v9 offset:7680
  s_waitcnt lgkmcnt(0)
  v_add_f32 v64, v64, v68
  v_add_f32 v65, v65, v69
  v_add_f32 v66, v66, v70
  v_add_f32 v67, v67, v71
  v_add_f32 v72, v72, v76
  v_add_f32 v73, v73, v77
  v_add_f32 v74, v74, v78
  v_add_f32 v75, v75, v79
  v_add_f32 v80, v80, v84
  v_add_f32 v81, v81, v85
  v_add_f32 v82, v82, v86
  v_add_f32 v83, v83, v87
  v_add_f32 v88, v88, v92
  v_add_f32 v89, v89, v93
  v_add_f32 v90, v90, v94
  v_add_f32 v91, v91, v95
  v_add_f32 v96, v96, v100
  v_add_f32 v97, v97, v101
  v_add_f32 v98, v98, v102
  v_add_f32 v99, v99, v103
  v_add_f32 v104, v104, v108
  v_add_f32 v105, v105, v109
  v_add_f32 v106, v106, v110
  v_add_f32 v107, v107, v111
  v_add_f32 v112, v112, v116
  v_add_f32 v113, v113, v117
  v_add_f32 v114, v114, v118
  v_add_f32 v115, v115, v119
  v_add_f32 v120, v120, v124
  v_add_f32 v121, v121, v125
  v_add_f32 v122, v122, v126
  v_add_f32 v123, v123, v127
  v_add_f32 v64, v64, v72
  v_add_f32 v65, v65, v73
  v_add_f32 v66, v66, v74
  v_add_f32 v67, v67, v75
  v_add_f32 v80, v80, v88
  v_add_f32 v81, v81, v89
  v_add_f32 v82, v82, v90
  v_add_f32 v83, v83, v91
  v_add_f32 v96, v96, v104
  v_add_f32 v97, v97, v105
  v_add_f32 v98, v98, v106
  v_add_f32 v99, v99, v107
  v_add_f32 v112, v112, v120
  v_add_f32 v113, v113, v121
  v_add_f32 v114, v114, v122
  v_add_f32 v115, v115, v123
  v_add_f32 v64, v64, v80
  v_add_f32 v65, v65, v81
  v_add_f32 v66, v66, v82
  v_add_f32 v67, v67, v83
  v_add_f32 v96, v96, v112
  v_add_f32 v97, v97, v113
  v_add_f32 v98, v98, v114
  v_add_f32 v99, v99, v115
  v_add_f32 v64, v64, v96
  v_add_f32 v65, v65, v97
  v_add_f32 v66, v66, v98
  v_add_f32 v67, v67, v99
  v_lshlrev_b32 v8, 2, v1
  v_xor_b32 v8, 128, v8
  ds_bpermute_b32 v96, v8, v64
  ds_bpermute_b32 v97, v8, v65
  ds_bpermute_b32 v98, v8, v66
  ds_bpermute_b32 v99, v8, v67
  s_waitcnt lgkmcnt(0)
  v_cvt_pk_bf16_f32 v20, v64, v96
  v_cvt_pk_bf16_f32 v21, v65, v97
  v_cvt_pk_bf16_f32 v22, v66, v98
  v_cvt_pk_bf16_f32 v23, v67, v99
  v_lshlrev_b32 v64, 16, v20
  v_and_b32 v96, 0xffff0000, v20
  v_lshlrev_b32 v65, 16, v21
  v_and_b32 v97, 0xffff0000, v21
  v_lshlrev_b32 v66, 16, v22
  v_and_b32 v98, 0xffff0000, v22
  v_lshlrev_b32 v67, 16, v23
  v_and_b32 v99, 0xffff0000, v23
  v_mul_f32 v24, 0xbfb8aa3b, v96
  v_mul_f32 v25, 0xbfb8aa3b, v97
  v_mul_f32 v26, 0xbfb8aa3b, v98
  v_mul_f32 v27, 0xbfb8aa3b, v99
  v_exp_f32 v24, v24
  v_exp_f32 v25, v25
  v_exp_f32 v26, v26
  v_exp_f32 v27, v27
  s_nop 0
  v_add_f32 v24, 1.0, v24
  v_add_f32 v25, 1.0, v25
  v_add_f32 v26, 1.0, v26
  v_add_f32 v27, 1.0, v27
  v_rcp_f32 v24, v24
  v_rcp_f32 v25, v25
  v_rcp_f32 v26, v26
  v_rcp_f32 v27, v27
  s_nop 0
  v_mul_f32 v24, v96, v24
  v_mul_f32 v25, v97, v25
  v_mul_f32 v26, v98, v26
  v_mul_f32 v27, v99, v27
  v_cvt_pk_bf16_f32 v24, v24, v24
  v_cvt_pk_bf16_f32 v25, v25, v25
  v_cvt_pk_bf16_f32 v26, v26, v26
  v_cvt_pk_bf16_f32 v27, v27, v27
  v_lshlrev_b32 v24, 16, v24
  v_lshlrev_b32 v25, 16, v25
  v_lshlrev_b32 v26, 16, v26
  v_lshlrev_b32 v27, 16, v27
  v_mul_f32 v24, v64, v24
  v_mul_f32 v25, v65, v25
  v_mul_f32 v26, v66, v26
  v_mul_f32 v27, v67, v27
  v_cvt_pk_bf16_f32 v24, v24, v24
  v_cvt_pk_bf16_f32 v25, v25, v25
  v_cvt_pk_bf16_f32 v26, v26, v26
  v_cvt_pk_bf16_f32 v27, v27, v27
  v_lshlrev_b32 v24, 16, v24
  v_lshlrev_b32 v16, 16, v16
  v_lshlrev_b32 v25, 16, v25
  v_lshlrev_b32 v17, 16, v17
  v_lshlrev_b32 v26, 16, v26
  v_lshlrev_b32 v18, 16, v18
  v_lshlrev_b32 v27, 16, v27
  v_lshlrev_b32 v19, 16, v19
  v_add_f32 v24, v16, v24
  v_add_f32 v25, v17, v25
  v_add_f32 v26, v18, v26
  v_add_f32 v27, v19, v27
  v_cvt_pk_bf16_f32 v24, v24, v24
  v_cvt_pk_bf16_f32 v25, v25, v25
  v_cvt_pk_bf16_f32 v26, v26, v26
  v_cvt_pk_bf16_f32 v27, v27, v27
  s_mov_b32 s92, 0xffffffff
  s_mov_b32 s93, 0
  s_mov_b64 exec, s[92:93]
  buffer_store_short v24, v13, s[56:59], s86 offen offset:0
  buffer_store_short v25, v13, s[56:59], s86 offen offset:16
  buffer_store_short v26, v13, s[56:59], s86 offen offset:32
  buffer_store_short v27, v13, s[56:59], s86 offen offset:48
  s_mov_b64 exec, -1
L_end:
L_end2:
  s_endpgm
.section .rodata,"a"
.p2align 6
.amdhsa_kernel recurrent_scan__gqa_block_cached__glu_gated_reglu__decode_kernel
  .amdhsa_next_free_vgpr 256
  .amdhsa_next_free_sgpr 102
  .amdhsa_accum_offset 256
  .amdhsa_group_segment_fixed_size 0
  .amdhsa_kernarg_size 96
  .amdhsa_user_sgpr_count 2
  .amdhsa_user_sgpr_kernarg_segment_ptr 1
  .amdhsa_system_sgpr_workgroup_id_x 1
  .amdhsa_float_denorm_mode_32 3
.end_amdhsa_kernel
```
